```python
import torch

def _softmax(x, axis=-1):
    return torch.softmax(x, dim=axis)

def _gelu(x):
    return torch.nn.functional.gelu(x, approximate='tanh')

def _silu(x):
    return torch.nn.functional.silu(x)

def _sigmoid(x):
    return torch.sigmoid(x)

def _layernorm(x, axis=-1, eps=1e-05):
    m = x.mean(dim=axis, keepdim=True)
    v = x.var(dim=axis, keepdim=True, unbiased=False)
    return (x - m) / torch.sqrt(v + eps)

def _scatter_add(tgt, idx, src, axis=0):
    return tgt.clone().index_add_(axis, idx, src)

def _segment_sum(src, seg, n):
    out = torch.zeros((n,) + src.shape[1:], dtype=src.dtype)
    return out.index_add_(0, seg, src)

def _pad(x, pw):
    flat = tuple((v for pair in reversed(pw) for v in pair))
    return torch.nn.functional.pad(x, flat)
kernel_name = 'adaLN_cond__gqa_block_cached__dense_activation_silu__decode'

def setup_inputs():

    _w = lambda a: (lambda t: t.to(torch.bfloat16) if t.is_floating_point() else t)(torch.as_tensor(a))

    def _A_setup():
        B, Sq, D = (1, 1, 512)
        Hq, Hkv, Sk, Dh = (32, 8, 65536, 128)
        assert Hq % Hkv == 0, (Hq, Hkv)
        return {'x': _w((lambda *s: torch.randn(*s, dtype=torch.bfloat16) * 0.1)(B, Sq, D)), 'k_cache': _w((lambda *s: torch.randn(*s, dtype=torch.bfloat16) * 0.8)(B, Hkv, Sk, Dh)), 'v_cache': _w((lambda *s: torch.randn(*s, dtype=torch.bfloat16) * 3.2)(B, Hkv, Sk, Dh)), 'wq': _w((lambda *s: torch.randn(*s, dtype=torch.bfloat16) * 0.8)(D, Hq * Dh) * D ** (-0.5)), 'wo': _w((lambda *s: torch.randn(*s, dtype=torch.bfloat16) * 3.2)(Hq * Dh, D) * (Hq * Dh) ** (-0.5))}
    _A_in = _A_setup()

    def _B_setup():
        B, S, D, F = (1, 1, 512, 1792)
        return {'x': _w((lambda *s: torch.randn(*s, dtype=torch.bfloat16) * 0.1)(B, S, D)), 'w1': _w((lambda *s: torch.randn(*s, dtype=torch.bfloat16) * 12.8)(D, F) * D ** (-0.5)), 'w2': _w((lambda *s: torch.randn(*s, dtype=torch.bfloat16) * 12.8)(F, D) * F ** (-0.5))}
    _B_in = _B_setup()
    return {'A_x': _A_in['x'], 'A_k_cache': _A_in['k_cache'], 'A_v_cache': _A_in['v_cache'], 'A_wq': _A_in['wq'], 'A_wo': _A_in['wo'], 'B_x': _B_in['x'], 'B_w1': _B_in['w1'], 'B_w2': _B_in['w2'], 'c': _w((lambda *s: torch.randn(*s, dtype=torch.bfloat16) * 0.2)(1, 512) * 8.0), 'w_mod': _w((lambda *s: torch.randn(*s, dtype=torch.bfloat16) * 0.2)(512, 6 * 512) * 512 ** (-0.5) * 8.0)}

def reference(A_x, A_k_cache, A_v_cache, A_wq, A_wo, B_x, B_w1, B_w2, c, w_mod):

    def _A_ref(x, k_cache, v_cache, wq, wo):
        B, Sq, D = x.shape
        Hq, Dh = (32, 128)
        Hkv = k_cache.shape[1]
        rep = Hq // Hkv
        q = (lambda x, *d: x.permute(*d))((x @ wq).reshape(B, Sq, Hq, Dh), 0, 2, 1, 3)
        k = (lambda x, n, axis: torch.repeat_interleave(x, n, dim=axis))(k_cache, rep, axis=1)
        v = (lambda x, n, axis: torch.repeat_interleave(x, n, dim=axis))(v_cache, rep, axis=1)
        scores = torch.einsum('bhqd,bhkd->bhqk', q, k) * Dh ** (-0.5)
        p = _softmax(scores, axis=-1)
        o = torch.einsum('bhqk,bhkd->bhqd', p, v)
        return (lambda x, *d: x.permute(*d))(o, 0, 2, 1, 3).reshape(B, Sq, Hq * Dh) @ wo

    def _B_ref(x, w1, w2):
        h = torch.einsum('bsd,df->bsf', x, w1)
        h = _silu(h)
        out = torch.einsum('bsf,fd->bsd', h, w2)
        return out
    x = A_x
    mod = (_silu(c) @ w_mod).reshape(c.shape[0], 6, 1, -1)
    sa, ca, ga, sb, cb, gb = (mod[:, 0].clone(), mod[:, 1].clone(), mod[:, 2].clone(), mod[:, 3].clone(), mod[:, 4].clone(), mod[:, 5].clone())
    h = _layernorm(x, axis=-1) * (1 + ca) + sa
    x = x + ga * _A_ref(h, A_k_cache, A_v_cache, A_wq, A_wo)
    h = _layernorm(x, axis=-1) * (1 + cb) + sb
    x = x + gb * _B_ref(h, B_w1, B_w2)
    return x
```

```asm
; @launch grid=(256,1,1) block=(512,1,1) lds=153600
.amdgcn_target "amdgcn-amd-amdhsa--gfx950"
.text
.globl adaLN_cond__gqa_block_cached__dense_activation_silu__decode_kernel
.p2align 8
.type adaLN_cond__gqa_block_cached__dense_activation_silu__decode_kernel,@function
adaLN_cond__gqa_block_cached__dense_activation_silu__decode_kernel:
    s_cmp_ge_u32 s2, 256
    s_cbranch_scc1 L_end
    s_load_dwordx16 s[16:31], s[0:1], 0
    s_load_dwordx8 s[32:39], s[0:1], 64
    s_load_dwordx2 s[8:9], s[0:1], 96
    v_lshrrev_b32 v1, 6, v0
    v_and_b32 v0, 63, v0
    v_readfirstlane_b32 s3, v1
    s_lshr_b32 s4, s2, 5
    s_and_b32 s5, s2, 31
    s_mov_b32 s14, 0x05040100
    s_mov_b32 s15, 0x07060302
    s_mov_b32 s56, 0x3e0293ee
    s_mov_b32 s57, 0x41000000
    s_mov_b32 s58, 0xbfb8aa3b
    v_lshlrev_b32 v1, 4, v0
    v_add_u32 v2, 0x1000, v1
    v_bfe_u32 v3, v0, 2, 2
    v_lshlrev_b32 v3, 8, v3
    v_lshrrev_b32 v28, 4, v0
    v_lshl_add_u32 v3, v28, 6, v3
    v_and_b32 v29, 3, v0
    v_lshl_add_u32 v3, v29, 4, v3
    v_add_u32 v4, 0x1000, v3
    v_and_b32 v29, 15, v0
    v_bfe_u32 v26, v0, 2, 2
    v_mov_b32 v5, 0
    v_mov_b32 v6, 0
    v_mov_b32 v24, 0x0000ffff
    v_mov_b32 v25, 0xffff0000
    v_cmp_eq_u32 vcc, 0, v26
    s_nop 1
    v_cndmask_b32 v5, v5, v24, vcc
    v_cmp_eq_u32 vcc, 1, v26
    s_nop 1
    v_cndmask_b32 v5, v5, v25, vcc
    v_cmp_eq_u32 vcc, 2, v26
    s_nop 1
    v_cndmask_b32 v6, v6, v24, vcc
    v_cmp_eq_u32 vcc, 3, v26
    s_nop 1
    v_cndmask_b32 v6, v6, v25, vcc
    v_mov_b32 v7, 0xf149f2ca
    v_mov_b32 v8, 0
    v_mov_b32 v9, 0
    v_mov_b32 v10, 0
    v_mov_b32 v11, 1
    v_mov_b32 v128, 0
    v_mov_b32 v129, 0
    v_mov_b32 v130, 0
    v_mov_b32 v131, 0
    v_mov_b32 v132, 0
    v_mov_b32 v133, 0
    v_mov_b32 v134, 0
    v_mov_b32 v135, 0
    v_mov_b32 v136, 0
    v_mov_b32 v137, 0
    v_mov_b32 v138, 0
    v_mov_b32 v139, 0
    v_mov_b32 v140, 0
    v_mov_b32 v141, 0
    v_mov_b32 v142, 0
    v_mov_b32 v143, 0
    v_mov_b32 v144, 0
    v_mov_b32 v145, 0
    v_mov_b32 v146, 0
    v_mov_b32 v147, 0
    v_mov_b32 v148, 0
    v_mov_b32 v149, 0
    v_mov_b32 v150, 0
    v_mov_b32 v151, 0
    v_mov_b32 v152, 0
    v_mov_b32 v153, 0
    v_mov_b32 v154, 0
    v_mov_b32 v155, 0
    v_mov_b32 v156, 0
    v_mov_b32 v157, 0
    v_mov_b32 v158, 0
    v_mov_b32 v159, 0
    v_lshrrev_b32 v27, 3, v29
    v_lshlrev_b32 v27, 5, v27
    v_lshl_add_u32 v27, v28, 3, v27
    v_and_b32 v26, 7, v29
    v_lshlrev_b32 v26, 4, v26
    v_and_b32 v25, 1, v29
    v_lshlrev_b32 v25, 5, v25
    v_lshl_add_u32 v25, v28, 3, v25
    s_lshl_b32 s82, s5, 3
    s_add_u32 s82, s82, s3
    s_lshl_b32 s82, s82, 13
    s_add_u32 s83, s82, 0x200000
    s_mul_i32 s90, s4, 1089536
    s_add_u32 s82, s82, s90
    s_and_b32 s82, s82, 0xffffff
    s_add_u32 s83, s83, s90
    s_and_b32 s83, s83, 0xffffff
    s_mul_i32 s59, s5, 3
    s_add_u32 s59, s59, s3
    s_add_u32 s59, s59, 512
    s_lshl_b32 s59, s59, 13
    s_cmp_lt_u32 s3, 3
    s_cselect_b32 s64, 1, 0
    s_lshr_b32 s7, s5, 3
    s_add_u32 s7, s7, s3
    s_and_b32 s7, s7, 3
    s_add_u32 s62, s7, 1568
    s_lshl_b32 s63, s4, 2
    s_add_u32 s63, s63, s7
    s_mul_i32 s63, s63, 4352
    s_add_u32 s63, s63, 4194304
    s_mov_b32 s89, s63
    s_mov_b32 s63, 11
    s_mov_b32 s96, 0
    s_mov_b32 s97, 0
    s_mov_b32 s98, 1
    s_mov_b32 s60, 1
    s_mov_b32 s61, 1
    v_mov_b32 v12, 0
    v_mov_b32 v13, 0
    v_mov_b32 v14, 0
    v_mov_b32 v15, 0
    ds_write_b128 v10, v[12:15] offset:21760
    ds_write_b128 v10, v[12:15] offset:21776
    s_waitcnt lgkmcnt(0)
    s_load_dword s86, s[8:9], 0
    s_barrier
    s_lshl_b32 s7, s4, 24
    s_add_u32 s40, s18, s7
    s_addc_u32 s41, s19, 0
    s_mov_b32 s42, 0x1000000
    s_mov_b32 s43, 0x20000
    s_add_u32 s44, s20, s7
    s_addc_u32 s45, s21, 0
    s_mov_b32 s46, 0x1000000
    s_mov_b32 s47, 0x20000
    s_mov_b32 s80, 0
    s_mov_b32 s81, 0
    s_cmp_lt_u32 s5, 6
    s_cbranch_scc1 L_roleA
    s_cmp_lt_u32 s5, 14
    s_cbranch_scc1 L_roleB
    s_cmp_lt_u32 s5, 22
    s_cbranch_scc1 L_roleT2
    s_and_b32 s7, s4, 1
    s_sub_u32 s7, 26, s7
    s_cmp_lt_u32 s5, s7
    s_cbranch_scc1 L_roleMLP
L_common0:
L_common:
    v_mov_b32 v10, s89
    s_cmp_eq_u32 s3, 0
    s_cbranch_scc1 L_pollq
    s_waitcnt vmcnt(5)
    buffer_load_dwordx4 a[0:3], v3, s[40:43], s82 offen offset:0 nt
    s_waitcnt vmcnt(5)
    buffer_load_dwordx4 a[4:7], v3, s[40:43], s82 offen offset:1024 nt
    s_waitcnt vmcnt(5)
    buffer_load_dwordx4 a[8:11], v3, s[40:43], s82 offen offset:2048 nt
    s_waitcnt vmcnt(5)
    buffer_load_dwordx4 a[12:15], v3, s[40:43], s82 offen offset:3072 nt
    s_waitcnt vmcnt(5)
    buffer_load_dwordx4 a[16:19], v4, s[40:43], s82 offen offset:0 nt
    s_waitcnt vmcnt(5)
    buffer_load_dwordx4 a[20:23], v4, s[40:43], s82 offen offset:1024 nt
    s_waitcnt vmcnt(5)
    buffer_load_dwordx4 a[24:27], v4, s[40:43], s82 offen offset:2048 nt
    s_waitcnt vmcnt(5)
    buffer_load_dwordx4 a[28:31], v4, s[40:43], s82 offen offset:3072 nt
    s_waitcnt vmcnt(5)
    buffer_load_dwordx4 v[64:67], v1, s[44:47], s82 offen offset:0 nt
    s_waitcnt vmcnt(5)
    buffer_load_dwordx4 v[68:71], v1, s[44:47], s82 offen offset:1024 nt
    s_waitcnt vmcnt(5)
    buffer_load_dwordx4 v[72:75], v1, s[44:47], s82 offen offset:2048 nt
    s_waitcnt vmcnt(5)
    buffer_load_dwordx4 v[76:79], v1, s[44:47], s82 offen offset:3072 nt
    s_waitcnt vmcnt(5)
    buffer_load_dwordx4 v[80:83], v2, s[44:47], s82 offen offset:0 nt
    s_waitcnt vmcnt(5)
    buffer_load_dwordx4 v[84:87], v2, s[44:47], s82 offen offset:1024 nt
    s_waitcnt vmcnt(5)
    buffer_load_dwordx4 v[88:91], v2, s[44:47], s82 offen offset:2048 nt
    s_waitcnt vmcnt(5)
    buffer_load_dwordx4 v[92:95], v2, s[44:47], s82 offen offset:3072 nt
    s_waitcnt vmcnt(5)
    buffer_load_dwordx4 a[32:35], v3, s[40:43], s83 offen offset:0 nt
    s_waitcnt vmcnt(5)
    buffer_load_dwordx4 a[36:39], v3, s[40:43], s83 offen offset:1024 nt
    s_waitcnt vmcnt(5)
    buffer_load_dwordx4 a[40:43], v3, s[40:43], s83 offen offset:2048 nt
    s_waitcnt vmcnt(5)
    buffer_load_dwordx4 a[44:47], v3, s[40:43], s83 offen offset:3072 nt
    s_waitcnt vmcnt(5)
    buffer_load_dwordx4 a[48:51], v4, s[40:43], s83 offen offset:0 nt
    s_waitcnt vmcnt(5)
    buffer_load_dwordx4 a[52:55], v4, s[40:43], s83 offen offset:1024 nt
    s_waitcnt vmcnt(5)
    buffer_load_dwordx4 a[56:59], v4, s[40:43], s83 offen offset:2048 nt
    s_waitcnt vmcnt(5)
    buffer_load_dwordx4 a[60:63], v4, s[40:43], s83 offen offset:3072 nt
    s_waitcnt vmcnt(5)
    buffer_load_dwordx4 v[96:99], v1, s[44:47], s83 offen offset:0 nt
    s_waitcnt vmcnt(5)
    buffer_load_dwordx4 v[100:103], v1, s[44:47], s83 offen offset:1024 nt
    s_waitcnt vmcnt(5)
    buffer_load_dwordx4 v[104:107], v1, s[44:47], s83 offen offset:2048 nt
    s_waitcnt vmcnt(5)
    buffer_load_dwordx4 v[108:111], v1, s[44:47], s83 offen offset:3072 nt
    s_waitcnt vmcnt(5)
    buffer_load_dwordx4 v[112:115], v2, s[44:47], s83 offen offset:0 nt
    s_waitcnt vmcnt(5)
    buffer_load_dwordx4 v[116:119], v2, s[44:47], s83 offen offset:1024 nt
    s_waitcnt vmcnt(5)
    buffer_load_dwordx4 v[120:123], v2, s[44:47], s83 offen offset:2048 nt
    s_waitcnt vmcnt(5)
    buffer_load_dwordx4 v[124:127], v2, s[44:47], s83 offen offset:3072 nt
    s_waitcnt lgkmcnt(0)
    s_mul_i32 s6, s86, 0x9e3779b1
    s_add_u32 s6, s6, 0x7f4a7c15
    v_mov_b32 v32, 0
    s_mov_b32 s7, 0
    s_branch L_go_2
L_poll_1:
    s_add_u32 s7, s7, 1
    s_cmp_ge_u32 s7, 200000
    s_cbranch_scc1 L_end
L_go_2:
    ds_read_b32 v33, v32 offset:21760
    s_waitcnt lgkmcnt(0)
    v_readfirstlane_b32 s65, v33
    s_nop 0
    s_cmp_eq_u32 s65, 0
    s_cbranch_scc1 L_poll_1
    ds_read_b128 v[12:15], v1 offset:0
    s_waitcnt lgkmcnt(0)
    s_branch L_haveq
L_pollq:
    s_setprio 3
    s_waitcnt lgkmcnt(0)
    s_mul_i32 s6, s86, 0x9e3779b1
    s_add_u32 s6, s6, 0x7f4a7c15
    v_and_b32 v32, 3, v0
    v_lshlrev_b32 v32, 9, v32
    v_lshl_add_u32 v32, v28, 7, v32
    v_bfe_u32 v33, v0, 2, 2
    v_lshl_add_u32 v32, v33, 5, v32
    s_lshl_b32 s7, s4, 11
    s_add_u32 s7, s7, 81920
    v_add_u32 v32, s7, v32
    v_mov_b32 v33, 65536
    s_mov_b32 s7, 0
    s_branch L_go_4
L_poll_3:
    s_add_u32 s7, s7, 1
    s_cmp_ge_u32 s7, 200000
    s_cbranch_scc1 L_end
L_go_4:
    s_mov_b64 exec, 1
    global_load_dwordx2 v[36:37], v33, s[8:9] sc1
    s_waitcnt vmcnt(0)
    v_cmp_eq_u32 vcc, s6, v37
    s_mov_b64 exec, -1
    s_cbranch_vccz L_poll_3
    s_mov_b32 s7, 0
    s_branch L_go_6
L_poll_5:
    s_add_u32 s7, s7, 1
    s_cmp_ge_u32 s7, 200000
    s_cbranch_scc1 L_end
L_go_6:
    global_load_dwordx4 v[36:39], v32, s[8:9] sc1
    global_load_dwordx4 v[40:43], v32, s[8:9] offset:16 sc1
    s_waitcnt vmcnt(0)
    v_min3_u32 v44, v37, v39, v41
    v_min_u32 v44, v44, v43
    v_max3_u32 v45, v37, v39, v41
    v_max_u32 v45, v45, v43
    v_cmp_ne_u32 vcc, s6, v44
    v_cmp_ne_u32 s[12:13], s6, v45
    s_nop 0
    s_or_b64 s[12:13], s[12:13], vcc
    s_cbranch_scc1 L_poll_5
    v_mov_b32 v12, v36
    v_mov_b32 v13, v38
    v_mov_b32 v14, v40
    v_mov_b32 v15, v42
    ds_write_b128 v1, v[12:15] offset:0
    v_mov_b32 v32, 0
    s_waitcnt lgkmcnt(0)
    ds_write_b32 v32, v11 offset:21760
    s_setprio 0
    buffer_load_dwordx4 a[0:3], v3, s[40:43], s82 offen offset:0 nt
    buffer_load_dwordx4 a[4:7], v3, s[40:43], s82 offen offset:1024 nt
    buffer_load_dwordx4 a[8:11], v3, s[40:43], s82 offen offset:2048 nt
    buffer_load_dwordx4 a[12:15], v3, s[40:43], s82 offen offset:3072 nt
    buffer_load_dwordx4 a[16:19], v4, s[40:43], s82 offen offset:0 nt
    buffer_load_dwordx4 a[20:23], v4, s[40:43], s82 offen offset:1024 nt
    buffer_load_dwordx4 a[24:27], v4, s[40:43], s82 offen offset:2048 nt
    buffer_load_dwordx4 a[28:31], v4, s[40:43], s82 offen offset:3072 nt
    buffer_load_dwordx4 v[64:67], v1, s[44:47], s82 offen offset:0 nt
    buffer_load_dwordx4 v[68:71], v1, s[44:47], s82 offen offset:1024 nt
    buffer_load_dwordx4 v[72:75], v1, s[44:47], s82 offen offset:2048 nt
    buffer_load_dwordx4 v[76:79], v1, s[44:47], s82 offen offset:3072 nt
    buffer_load_dwordx4 v[80:83], v2, s[44:47], s82 offen offset:0 nt
    buffer_load_dwordx4 v[84:87], v2, s[44:47], s82 offen offset:1024 nt
    buffer_load_dwordx4 v[88:91], v2, s[44:47], s82 offen offset:2048 nt
    buffer_load_dwordx4 v[92:95], v2, s[44:47], s82 offen offset:3072 nt
    buffer_load_dwordx4 a[32:35], v3, s[40:43], s83 offen offset:0 nt
    buffer_load_dwordx4 a[36:39], v3, s[40:43], s83 offen offset:1024 nt
    buffer_load_dwordx4 a[40:43], v3, s[40:43], s83 offen offset:2048 nt
    buffer_load_dwordx4 a[44:47], v3, s[40:43], s83 offen offset:3072 nt
    buffer_load_dwordx4 a[48:51], v4, s[40:43], s83 offen offset:0 nt
    buffer_load_dwordx4 a[52:55], v4, s[40:43], s83 offen offset:1024 nt
    buffer_load_dwordx4 a[56:59], v4, s[40:43], s83 offen offset:2048 nt
    buffer_load_dwordx4 a[60:63], v4, s[40:43], s83 offen offset:3072 nt
    buffer_load_dwordx4 v[96:99], v1, s[44:47], s83 offen offset:0 nt
    buffer_load_dwordx4 v[100:103], v1, s[44:47], s83 offen offset:1024 nt
    buffer_load_dwordx4 v[104:107], v1, s[44:47], s83 offen offset:2048 nt
    buffer_load_dwordx4 v[108:111], v1, s[44:47], s83 offen offset:3072 nt
    buffer_load_dwordx4 v[112:115], v2, s[44:47], s83 offen offset:0 nt
    buffer_load_dwordx4 v[116:119], v2, s[44:47], s83 offen offset:1024 nt
    buffer_load_dwordx4 v[120:123], v2, s[44:47], s83 offen offset:2048 nt
    buffer_load_dwordx4 v[124:127], v2, s[44:47], s83 offen offset:3072 nt
L_haveq:
    s_waitcnt vmcnt(16)
    s_mov_b32 s65, 0
    s_branch L_entryA
L_stepA:
    s_cmp_eq_u32 s60, 0
    s_cbranch_scc1 L_loopdone
    s_waitcnt vmcnt(8)
    s_cmp_eq_u32 s63, 0
    s_cbranch_scc1 L_dynA
    s_mov_b32 s61, s64
    s_mov_b32 s7, s59
    s_add_u32 s59, s59, 786432
    s_sub_u32 s63, s63, 1
    s_branch L_chkA
L_dynA:
    s_waitcnt lgkmcnt(0)
    s_mov_b32 s7, s91
    s_cmp_lt_u32 s7, 120
    s_cselect_b32 s61, 1, 0
    s_lshl_b32 s7, s7, 2
    s_add_u32 s7, s7, s62
    s_lshl_b32 s7, s7, 13
L_chkA:
    s_add_u32 s7, s7, s90
    s_and_b32 s7, s7, 0xffffff
    s_cmp_lg_u32 s61, 0
    s_cbranch_scc1 L_refillA
    s_waitcnt vmcnt(0)
    s_branch L_entryA
L_refillA:
    s_cmp_lg_u32 s63, 0
    s_cbranch_scc1 L_noclaimA
    s_mov_b32 s91, 1
    s_atomic_add s91, s[8:9], s89 glc
L_noclaimA:
    buffer_load_dwordx4 a[32:35], v3, s[40:43], s7 offen offset:0 nt
    buffer_load_dwordx4 a[36:39], v3, s[40:43], s7 offen offset:1024 nt
    buffer_load_dwordx4 a[40:43], v3, s[40:43], s7 offen offset:2048 nt
    buffer_load_dwordx4 a[44:47], v3, s[40:43], s7 offen offset:3072 nt
    buffer_load_dwordx4 a[48:51], v4, s[40:43], s7 offen offset:0 nt
    buffer_load_dwordx4 a[52:55], v4, s[40:43], s7 offen offset:1024 nt
    buffer_load_dwordx4 a[56:59], v4, s[40:43], s7 offen offset:2048 nt
    buffer_load_dwordx4 a[60:63], v4, s[40:43], s7 offen offset:3072 nt
    buffer_load_dwordx4 v[96:99], v1, s[44:47], s7 offen offset:0 nt
    buffer_load_dwordx4 v[100:103], v1, s[44:47], s7 offen offset:1024 nt
    buffer_load_dwordx4 v[104:107], v1, s[44:47], s7 offen offset:2048 nt
    buffer_load_dwordx4 v[108:111], v1, s[44:47], s7 offen offset:3072 nt
    buffer_load_dwordx4 v[112:115], v2, s[44:47], s7 offen offset:0 nt
    buffer_load_dwordx4 v[116:119], v2, s[44:47], s7 offen offset:1024 nt
    buffer_load_dwordx4 v[120:123], v2, s[44:47], s7 offen offset:2048 nt
    buffer_load_dwordx4 v[124:127], v2, s[44:47], s7 offen offset:3072 nt
L_entryA:
    v_mfma_f32_16x16x32_bf16 v[32:35], a[0:3], v[12:15], 0
    v_mfma_f32_16x16x32_bf16 v[36:39], a[4:7], v[12:15], 0
    v_mfma_f32_16x16x32_bf16 v[40:43], a[8:11], v[12:15], 0
    v_mfma_f32_16x16x32_bf16 v[44:47], a[12:15], v[12:15], 0
    v_mfma_f32_16x16x32_bf16 v[48:51], a[16:19], v[12:15], 0
    v_mfma_f32_16x16x32_bf16 v[52:55], a[20:23], v[12:15], 0
    v_mfma_f32_16x16x32_bf16 v[56:59], a[24:27], v[12:15], 0
    v_mfma_f32_16x16x32_bf16 v[60:63], a[28:31], v[12:15], 0
    s_nop 0
    v_add_f32_dpp v32, v33, v32 row_ror:12 row_mask:0xf bank_mask:0xf
    v_add_f32_dpp v37, v36, v37 row_ror:4 row_mask:0xf bank_mask:0xf
    v_add_f32_dpp v42, v40, v42 row_ror:8 row_mask:0xf bank_mask:0xf
    v_add_f32_dpp v47, v44, v47 row_ror:12 row_mask:0xf bank_mask:0xf
    v_add_f32_dpp v48, v49, v48 row_ror:12 row_mask:0xf bank_mask:0xf
    v_add_f32_dpp v53, v52, v53 row_ror:4 row_mask:0xf bank_mask:0xf
    v_add_f32_dpp v58, v56, v58 row_ror:8 row_mask:0xf bank_mask:0xf
    v_add_f32_dpp v63, v60, v63 row_ror:12 row_mask:0xf bank_mask:0xf
    v_add_f32_dpp v32, v34, v32 row_ror:8 row_mask:0xf bank_mask:0xf
    v_add_f32_dpp v37, v38, v37 row_ror:12 row_mask:0xf bank_mask:0xf
    v_add_f32_dpp v42, v41, v42 row_ror:4 row_mask:0xf bank_mask:0xf
    v_add_f32_dpp v47, v45, v47 row_ror:8 row_mask:0xf bank_mask:0xf
    v_add_f32_dpp v48, v50, v48 row_ror:8 row_mask:0xf bank_mask:0xf
    v_add_f32_dpp v53, v54, v53 row_ror:12 row_mask:0xf bank_mask:0xf
    v_add_f32_dpp v58, v57, v58 row_ror:4 row_mask:0xf bank_mask:0xf
    v_add_f32_dpp v63, v61, v63 row_ror:8 row_mask:0xf bank_mask:0xf
    v_add_f32_dpp v20, v35, v32 row_ror:4 row_mask:0xf bank_mask:0x1
    v_add_f32_dpp v20, v39, v37 row_ror:8 row_mask:0xf bank_mask:0x2
    v_add_f32_dpp v20, v43, v42 row_ror:12 row_mask:0xf bank_mask:0x4
    v_add_f32_dpp v20, v46, v47 row_ror:4 row_mask:0xf bank_mask:0x8
    v_add_f32_dpp v21, v51, v48 row_ror:4 row_mask:0xf bank_mask:0x1
    v_add_f32_dpp v21, v55, v53 row_ror:8 row_mask:0xf bank_mask:0x2
    v_add_f32_dpp v21, v59, v58 row_ror:12 row_mask:0xf bank_mask:0x4
    v_add_f32_dpp v21, v62, v63 row_ror:4 row_mask:0xf bank_mask:0x8
    v_fma_f32 v22, v20, s56, -v7
    v_fma_f32 v23, v21, s56, -v7
    v_max_f32 v24, v22, v23
    v_cmp_lt_f32 vcc, s57, v24
    s_cbranch_vccz L_norareA
    s_call_b64 s[10:11], L_rare
L_norareA:
    v_exp_f32 v22, v22
    v_exp_f32 v23, v23
    s_nop 0
    v_cvt_pk_bf16_f32 v24, v22, v22
    v_cvt_pk_bf16_f32 v25, v23, v23
    v_add_f32 v8, v8, v22
    v_and_b32 v16, v24, v5
    v_and_b32 v17, v24, v6
    v_and_b32 v18, v25, v5
    v_and_b32 v19, v25, v6
    v_add_f32 v8, v8, v23
    s_waitcnt vmcnt(16)
    v_perm_b32 v32, v68, v64, s14
    v_perm_b32 v33, v76, v72, s14
    v_perm_b32 v34, v84, v80, s14
    v_perm_b32 v35, v92, v88, s14
    v_perm_b32 v36, v68, v64, s15
    v_perm_b32 v37, v76, v72, s15
    v_perm_b32 v38, v84, v80, s15
    v_perm_b32 v39, v92, v88, s15
    v_perm_b32 v40, v69, v65, s14
    v_perm_b32 v41, v77, v73, s14
    v_perm_b32 v42, v85, v81, s14
    v_perm_b32 v43, v93, v89, s14
    v_mfma_f32_16x16x32_bf16 v[128:131], v[16:19], v[32:35], v[128:131]
    v_perm_b32 v32, v69, v65, s15
    v_perm_b32 v33, v77, v73, s15
    v_perm_b32 v34, v85, v81, s15
    v_perm_b32 v35, v93, v89, s15
    v_mfma_f32_16x16x32_bf16 v[132:135], v[16:19], v[36:39], v[132:135]
    v_perm_b32 v36, v70, v66, s14
    v_perm_b32 v37, v78, v74, s14
    v_perm_b32 v38, v86, v82, s14
    v_perm_b32 v39, v94, v90, s14
    v_mfma_f32_16x16x32_bf16 v[136:139], v[16:19], v[40:43], v[136:139]
    v_perm_b32 v40, v70, v66, s15
    v_perm_b32 v41, v78, v74, s15
    v_perm_b32 v42, v86, v82, s15
    v_perm_b32 v43, v94, v90, s15
    v_mfma_f32_16x16x32_bf16 v[140:143], v[16:19], v[32:35], v[140:143]
    v_perm_b32 v32, v71, v67, s14
    v_perm_b32 v33, v79, v75, s14
    v_perm_b32 v34, v87, v83, s14
    v_perm_b32 v35, v95, v91, s14
    v_mfma_f32_16x16x32_bf16 v[144:147], v[16:19], v[36:39], v[144:147]
    v_perm_b32 v36, v71, v67, s15
    v_perm_b32 v37, v79, v75, s15
    v_perm_b32 v38, v87, v83, s15
    v_perm_b32 v39, v95, v91, s15
    v_mfma_f32_16x16x32_bf16 v[148:151], v[16:19], v[40:43], v[148:151]
    v_mfma_f32_16x16x32_bf16 v[152:155], v[16:19], v[32:35], v[152:155]
    v_mfma_f32_16x16x32_bf16 v[156:159], v[16:19], v[36:39], v[156:159]
L_stepB:
    s_cmp_eq_u32 s61, 0
    s_cbranch_scc1 L_loopdone
    s_waitcnt vmcnt(8)
    s_cmp_eq_u32 s63, 0
    s_cbranch_scc1 L_dynB
    s_mov_b32 s60, s64
    s_mov_b32 s7, s59
    s_add_u32 s59, s59, 786432
    s_sub_u32 s63, s63, 1
    s_branch L_chkB
L_dynB:
    s_waitcnt lgkmcnt(0)
    s_mov_b32 s7, s91
    s_cmp_lt_u32 s7, 120
    s_cselect_b32 s60, 1, 0
    s_lshl_b32 s7, s7, 2
    s_add_u32 s7, s7, s62
    s_lshl_b32 s7, s7, 13
L_chkB:
    s_add_u32 s7, s7, s90
    s_and_b32 s7, s7, 0xffffff
    s_cmp_lg_u32 s60, 0
    s_cbranch_scc1 L_refillB
    s_waitcnt vmcnt(0)
    s_branch L_entryB
L_refillB:
    s_cmp_lg_u32 s63, 0
    s_cbranch_scc1 L_noclaimB
    s_mov_b32 s91, 1
    s_atomic_add s91, s[8:9], s89 glc
L_noclaimB:
    buffer_load_dwordx4 a[0:3], v3, s[40:43], s7 offen offset:0 nt
    buffer_load_dwordx4 a[4:7], v3, s[40:43], s7 offen offset:1024 nt
    buffer_load_dwordx4 a[8:11], v3, s[40:43], s7 offen offset:2048 nt
    buffer_load_dwordx4 a[12:15], v3, s[40:43], s7 offen offset:3072 nt
    buffer_load_dwordx4 a[16:19], v4, s[40:43], s7 offen offset:0 nt
    buffer_load_dwordx4 a[20:23], v4, s[40:43], s7 offen offset:1024 nt
    buffer_load_dwordx4 a[24:27], v4, s[40:43], s7 offen offset:2048 nt
    buffer_load_dwordx4 a[28:31], v4, s[40:43], s7 offen offset:3072 nt
    buffer_load_dwordx4 v[64:67], v1, s[44:47], s7 offen offset:0 nt
    buffer_load_dwordx4 v[68:71], v1, s[44:47], s7 offen offset:1024 nt
    buffer_load_dwordx4 v[72:75], v1, s[44:47], s7 offen offset:2048 nt
    buffer_load_dwordx4 v[76:79], v1, s[44:47], s7 offen offset:3072 nt
    buffer_load_dwordx4 v[80:83], v2, s[44:47], s7 offen offset:0 nt
    buffer_load_dwordx4 v[84:87], v2, s[44:47], s7 offen offset:1024 nt
    buffer_load_dwordx4 v[88:91], v2, s[44:47], s7 offen offset:2048 nt
    buffer_load_dwordx4 v[92:95], v2, s[44:47], s7 offen offset:3072 nt
L_entryB:
    v_mfma_f32_16x16x32_bf16 v[32:35], a[32:35], v[12:15], 0
    v_mfma_f32_16x16x32_bf16 v[36:39], a[36:39], v[12:15], 0
    v_mfma_f32_16x16x32_bf16 v[40:43], a[40:43], v[12:15], 0
    v_mfma_f32_16x16x32_bf16 v[44:47], a[44:47], v[12:15], 0
    v_mfma_f32_16x16x32_bf16 v[48:51], a[48:51], v[12:15], 0
    v_mfma_f32_16x16x32_bf16 v[52:55], a[52:55], v[12:15], 0
    v_mfma_f32_16x16x32_bf16 v[56:59], a[56:59], v[12:15], 0
    v_mfma_f32_16x16x32_bf16 v[60:63], a[60:63], v[12:15], 0
    s_nop 0
    v_add_f32_dpp v32, v33, v32 row_ror:12 row_mask:0xf bank_mask:0xf
    v_add_f32_dpp v37, v36, v37 row_ror:4 row_mask:0xf bank_mask:0xf
    v_add_f32_dpp v42, v40, v42 row_ror:8 row_mask:0xf bank_mask:0xf
    v_add_f32_dpp v47, v44, v47 row_ror:12 row_mask:0xf bank_mask:0xf
    v_add_f32_dpp v48, v49, v48 row_ror:12 row_mask:0xf bank_mask:0xf
    v_add_f32_dpp v53, v52, v53 row_ror:4 row_mask:0xf bank_mask:0xf
    v_add_f32_dpp v58, v56, v58 row_ror:8 row_mask:0xf bank_mask:0xf
    v_add_f32_dpp v63, v60, v63 row_ror:12 row_mask:0xf bank_mask:0xf
    v_add_f32_dpp v32, v34, v32 row_ror:8 row_mask:0xf bank_mask:0xf
    v_add_f32_dpp v37, v38, v37 row_ror:12 row_mask:0xf bank_mask:0xf
    v_add_f32_dpp v42, v41, v42 row_ror:4 row_mask:0xf bank_mask:0xf
    v_add_f32_dpp v47, v45, v47 row_ror:8 row_mask:0xf bank_mask:0xf
    v_add_f32_dpp v48, v50, v48 row_ror:8 row_mask:0xf bank_mask:0xf
    v_add_f32_dpp v53, v54, v53 row_ror:12 row_mask:0xf bank_mask:0xf
    v_add_f32_dpp v58, v57, v58 row_ror:4 row_mask:0xf bank_mask:0xf
    v_add_f32_dpp v63, v61, v63 row_ror:8 row_mask:0xf bank_mask:0xf
    v_add_f32_dpp v20, v35, v32 row_ror:4 row_mask:0xf bank_mask:0x1
    v_add_f32_dpp v20, v39, v37 row_ror:8 row_mask:0xf bank_mask:0x2
    v_add_f32_dpp v20, v43, v42 row_ror:12 row_mask:0xf bank_mask:0x4
    v_add_f32_dpp v20, v46, v47 row_ror:4 row_mask:0xf bank_mask:0x8
    v_add_f32_dpp v21, v51, v48 row_ror:4 row_mask:0xf bank_mask:0x1
    v_add_f32_dpp v21, v55, v53 row_ror:8 row_mask:0xf bank_mask:0x2
    v_add_f32_dpp v21, v59, v58 row_ror:12 row_mask:0xf bank_mask:0x4
    v_add_f32_dpp v21, v62, v63 row_ror:4 row_mask:0xf bank_mask:0x8
    v_fma_f32 v22, v20, s56, -v7
    v_fma_f32 v23, v21, s56, -v7
    v_max_f32 v24, v22, v23
    v_cmp_lt_f32 vcc, s57, v24
    s_cbranch_vccz L_norareB
    s_call_b64 s[10:11], L_rare
L_norareB:
    v_exp_f32 v22, v22
    v_exp_f32 v23, v23
    s_nop 0
    v_cvt_pk_bf16_f32 v24, v22, v22
    v_cvt_pk_bf16_f32 v25, v23, v23
    v_add_f32 v8, v8, v22
    v_and_b32 v16, v24, v5
    v_and_b32 v17, v24, v6
    v_and_b32 v18, v25, v5
    v_and_b32 v19, v25, v6
    v_add_f32 v8, v8, v23
    s_waitcnt vmcnt(16)
    v_perm_b32 v32, v100, v96, s14
    v_perm_b32 v33, v108, v104, s14
    v_perm_b32 v34, v116, v112, s14
    v_perm_b32 v35, v124, v120, s14
    v_perm_b32 v36, v100, v96, s15
    v_perm_b32 v37, v108, v104, s15
    v_perm_b32 v38, v116, v112, s15
    v_perm_b32 v39, v124, v120, s15
    v_perm_b32 v40, v101, v97, s14
    v_perm_b32 v41, v109, v105, s14
    v_perm_b32 v42, v117, v113, s14
    v_perm_b32 v43, v125, v121, s14
    v_mfma_f32_16x16x32_bf16 v[128:131], v[16:19], v[32:35], v[128:131]
    v_perm_b32 v32, v101, v97, s15
    v_perm_b32 v33, v109, v105, s15
    v_perm_b32 v34, v117, v113, s15
    v_perm_b32 v35, v125, v121, s15
    v_mfma_f32_16x16x32_bf16 v[132:135], v[16:19], v[36:39], v[132:135]
    v_perm_b32 v36, v102, v98, s14
    v_perm_b32 v37, v110, v106, s14
    v_perm_b32 v38, v118, v114, s14
    v_perm_b32 v39, v126, v122, s14
    v_mfma_f32_16x16x32_bf16 v[136:139], v[16:19], v[40:43], v[136:139]
    v_perm_b32 v40, v102, v98, s15
    v_perm_b32 v41, v110, v106, s15
    v_perm_b32 v42, v118, v114, s15
    v_perm_b32 v43, v126, v122, s15
    v_mfma_f32_16x16x32_bf16 v[140:143], v[16:19], v[32:35], v[140:143]
    v_perm_b32 v32, v103, v99, s14
    v_perm_b32 v33, v111, v107, s14
    v_perm_b32 v34, v119, v115, s14
    v_perm_b32 v35, v127, v123, s14
    v_mfma_f32_16x16x32_bf16 v[144:147], v[16:19], v[36:39], v[144:147]
    v_perm_b32 v36, v103, v99, s15
    v_perm_b32 v37, v111, v107, s15
    v_perm_b32 v38, v119, v115, s15
    v_perm_b32 v39, v127, v123, s15
    v_mfma_f32_16x16x32_bf16 v[148:151], v[16:19], v[40:43], v[148:151]
    v_mfma_f32_16x16x32_bf16 v[152:155], v[16:19], v[32:35], v[152:155]
    v_mfma_f32_16x16x32_bf16 v[156:159], v[16:19], v[36:39], v[156:159]
    s_branch L_stepA
L_rare:
    s_nop 4
    v_mul_f32 v22, s56, v20
    v_mul_f32 v23, s56, v21
    v_max_f32 v24, v22, v23
    s_nop 1
    v_max_f32_dpp v24, v24, v24 row_ror:4 row_mask:0xf bank_mask:0xf
    s_nop 1
    v_max_f32_dpp v24, v24, v24 row_ror:8 row_mask:0xf bank_mask:0xf
    v_mov_b32 v25, v24
    s_nop 1
    v_permlane16_swap_b32 v24, v25
    v_max_f32 v24, v24, v25
    v_mov_b32 v25, v24
    s_nop 1
    v_permlane32_swap_b32 v24, v25
    v_max_f32 v24, v24, v25
    v_max_f32 v24, v24, v7
    v_sub_f32 v25, v7, v24
    v_exp_f32 v25, v25
    v_mov_b32 v7, v24
    v_sub_f32 v22, v22, v24
    v_sub_f32 v23, v23, v24
    v_mul_f32 v8, v8, v25
    v_readlane_b32 s66, v25, 0
    v_readlane_b32 s67, v25, 1
    v_readlane_b32 s68, v25, 2
    v_readlane_b32 s69, v25, 3
    v_mul_f32 v128, s66, v128
    v_mul_f32 v129, s67, v129
    v_mul_f32 v130, s68, v130
    v_mul_f32 v131, s69, v131
    v_mul_f32 v132, s66, v132
    v_mul_f32 v133, s67, v133
    v_mul_f32 v134, s68, v134
    v_mul_f32 v135, s69, v135
    v_mul_f32 v136, s66, v136
    v_mul_f32 v137, s67, v137
    v_mul_f32 v138, s68, v138
    v_mul_f32 v139, s69, v139
    v_mul_f32 v140, s66, v140
    v_mul_f32 v141, s67, v141
    v_mul_f32 v142, s68, v142
    v_mul_f32 v143, s69, v143
    v_mul_f32 v144, s66, v144
    v_mul_f32 v145, s67, v145
    v_mul_f32 v146, s68, v146
    v_mul_f32 v147, s69, v147
    v_mul_f32 v148, s66, v148
    v_mul_f32 v149, s67, v149
    v_mul_f32 v150, s68, v150
    v_mul_f32 v151, s69, v151
    v_mul_f32 v152, s66, v152
    v_mul_f32 v153, s67, v153
    v_mul_f32 v154, s68, v154
    v_mul_f32 v155, s69, v155
    v_mul_f32 v156, s66, v156
    v_mul_f32 v157, s67, v157
    v_mul_f32 v158, s68, v158
    v_mul_f32 v159, s69, v159
    s_nop 1
    s_setpc_b64 s[10:11]
L_loopdone:
    s_nop 7
    s_waitcnt vmcnt(0) lgkmcnt(0)
    v_add_f32_dpp v8, v8, v8 row_ror:4 row_mask:0xf bank_mask:0xf
    v_permlane32_swap_b32 v128, v130
    v_permlane32_swap_b32 v129, v131
    v_permlane32_swap_b32 v132, v134
    v_permlane32_swap_b32 v133, v135
    v_permlane32_swap_b32 v136, v138
    v_permlane32_swap_b32 v137, v139
    v_permlane32_swap_b32 v140, v142
    v_permlane32_swap_b32 v141, v143
    v_permlane32_swap_b32 v144, v146
    v_permlane32_swap_b32 v145, v147
    v_permlane32_swap_b32 v148, v150
    v_permlane32_swap_b32 v149, v151
    v_permlane32_swap_b32 v152, v154
    v_permlane32_swap_b32 v153, v155
    v_permlane32_swap_b32 v156, v158
    v_permlane32_swap_b32 v157, v159
    v_add_f32_dpp v8, v8, v8 row_ror:8 row_mask:0xf bank_mask:0xf
    v_add_f32 v128, v128, v130
    v_add_f32 v129, v129, v131
    v_add_f32 v132, v132, v134
    v_add_f32 v133, v133, v135
    v_add_f32 v136, v136, v138
    v_add_f32 v137, v137, v139
    v_add_f32 v140, v140, v142
    v_add_f32 v141, v141, v143
    v_add_f32 v144, v144, v146
    v_add_f32 v145, v145, v147
    v_add_f32 v148, v148, v150
    v_add_f32 v149, v149, v151
    v_add_f32 v152, v152, v154
    v_add_f32 v153, v153, v155
    v_add_f32 v156, v156, v158
    v_add_f32 v157, v157, v159
    v_mov_b32 v24, v8
    v_lshlrev_b32 v32, 5, v0
    s_lshl_b32 s7, s3, 11
    v_permlane16_swap_b32 v8, v24
    v_permlane16_swap_b32 v128, v129
    v_permlane16_swap_b32 v132, v133
    v_permlane16_swap_b32 v136, v137
    v_permlane16_swap_b32 v140, v141
    v_permlane16_swap_b32 v144, v145
    v_permlane16_swap_b32 v148, v149
    v_permlane16_swap_b32 v152, v153
    v_permlane16_swap_b32 v156, v157
    v_add_f32 v8, v8, v24
    v_add_u32 v33, s7, v32
    v_add_f32 v96, v128, v129
    v_add_f32 v97, v132, v133
    v_add_f32 v98, v136, v137
    v_add_f32 v99, v140, v141
    v_add_f32 v100, v144, v145
    v_add_f32 v101, v148, v149
    v_add_f32 v102, v152, v153
    v_add_f32 v103, v156, v157
    v_mov_b32 v24, v8
    ds_write_b128 v33, v[96:99] offset:1024
    ds_write_b128 v33, v[100:103] offset:1040
    v_permlane32_swap_b32 v8, v24
    s_lshl_b32 s7, s3, 2
    v_add_u32 v33, s7, v32
    v_add_f32 v8, v8, v24
    s_mov_b64 exec, 0xf
    ds_write_b32 v33, v7 offset:17408
    ds_write_b32 v33, v8 offset:17536
    s_mov_b64 exec, -1
    s_lshl_b32 s7, s3, 5
    v_mov_b32 v33, s7
    s_lshl_b32 s7, s3, 9
    v_lshl_add_u32 v34, v0, 3, s7
    s_waitcnt lgkmcnt(0)
    s_barrier
    s_cmp_ge_u32 s3, 4
    s_cbranch_scc1 L_pubdone
    ds_read_b128 v[36:39], v33 offset:17408
    ds_read_b128 v[40:43], v33 offset:17424
    ds_read_b64 v[64:65], v34 offset:1024
    ds_read_b64 v[66:67], v34 offset:3072
    ds_read_b64 v[68:69], v34 offset:5120
    ds_read_b64 v[70:71], v34 offset:7168
    ds_read_b64 v[72:73], v34 offset:9216
    ds_read_b64 v[74:75], v34 offset:11264
    ds_read_b64 v[76:77], v34 offset:13312
    ds_read_b64 v[78:79], v34 offset:15360
    ds_read_b128 v[44:47], v33 offset:17536
    ds_read_b128 v[48:51], v33 offset:17552
    s_lshl_b32 s7, s2, 11
    s_add_u32 s7, s7, 131072
    v_add_u32 v34, s7, v34
    v_mov_b32 v53, s6
    v_mov_b32 v61, s6
    v_mov_b32 v63, s6
    s_waitcnt lgkmcnt(10)
    v_max3_f32 v60, v36, v37, v38
    v_max3_f32 v54, v39, v40, v41
    v_max3_f32 v60, v60, v42, v43
    v_max_f32 v60, v60, v54
    v_sub_f32 v36, v36, v60
    v_sub_f32 v37, v37, v60
    v_sub_f32 v38, v38, v60
    v_sub_f32 v39, v39, v60
    v_sub_f32 v40, v40, v60
    v_sub_f32 v41, v41, v60
    v_sub_f32 v42, v42, v60
    v_sub_f32 v43, v43, v60
    v_exp_f32 v36, v36
    v_exp_f32 v37, v37
    v_exp_f32 v38, v38
    v_exp_f32 v39, v39
    v_exp_f32 v40, v40
    v_exp_f32 v41, v41
    v_exp_f32 v42, v42
    v_exp_f32 v43, v43
    s_waitcnt lgkmcnt(2)
    v_mul_f32 v54, v36, v64
    v_mul_f32 v55, v36, v65
    v_mul_f32 v56, v37, v66
    v_mul_f32 v57, v37, v67
    v_fmac_f32 v54, v38, v68
    v_fmac_f32 v55, v38, v69
    v_fmac_f32 v56, v39, v70
    v_fmac_f32 v57, v39, v71
    v_fmac_f32 v54, v40, v72
    v_fmac_f32 v55, v40, v73
    v_fmac_f32 v56, v41, v74
    v_fmac_f32 v57, v41, v75
    v_fmac_f32 v54, v42, v76
    v_fmac_f32 v55, v42, v77
    v_fmac_f32 v56, v43, v78
    v_fmac_f32 v57, v43, v79
    v_add_f32 v54, v54, v56
    v_add_f32 v55, v55, v57
    v_cvt_pk_bf16_f32 v52, v54, v55
    global_store_dwordx2 v34, v[52:53], s[8:9] offset:0 sc1
    s_waitcnt lgkmcnt(0)
    v_mul_f32 v62, v36, v44
    v_fmac_f32 v62, v37, v45
    v_fmac_f32 v62, v38, v46
    v_fmac_f32 v62, v39, v47
    v_fmac_f32 v62, v40, v48
    v_fmac_f32 v62, v41, v49
    v_fmac_f32 v62, v42, v50
    v_fmac_f32 v62, v43, v51
    s_lshl_b32 s7, s4, 2
    s_add_u32 s7, s7, s3
    s_lshl_b32 s7, s7, 5
    s_add_u32 s7, s7, s5
    s_lshl_b32 s7, s7, 4
    s_add_u32 s7, s7, 98304
    v_mov_b32 v34, s7
    s_mov_b64 exec, 1
    global_store_dwordx4 v34, v[60:63], s[8:9] offset:0 sc1
    s_mov_b64 exec, -1
L_pubdone:
    s_cmp_eq_u32 s80, 3
    s_cbranch_scc1 L_T2
    s_cmp_eq_u32 s80, 4
    s_cbranch_scc1 L_MLP
L_end:
    s_endpgm
L_T2:
    s_lshl_b32 s7, s3, 13
    s_add_u32 s7, s7, 22528
    v_add_u32 v24, s7, v1
    ds_read_b128 v[128:131], v24 offset:0
    ds_read_b128 v[132:135], v24 offset:1024
    ds_read_b128 v[136:139], v24 offset:2048
    ds_read_b128 v[140:143], v24 offset:3072
    ds_read_b128 v[144:147], v24 offset:4096
    ds_read_b128 v[148:151], v24 offset:5120
    ds_read_b128 v[152:155], v24 offset:6144
    ds_read_b128 v[156:159], v24 offset:7168
    s_and_b32 s66, s3, 1
    s_lshr_b32 s67, s3, 1
    s_lshr_b32 s68, s81, 2
    s_and_b32 s69, s68, 1
    s_lshl_b32 s69, s69, 1
    s_add_u32 s69, s69, s66
    s_lshl_b32 s7, s4, 5
    s_lshl_b32 s70, s67, 3
    s_add_u32 s7, s7, s70
    s_lshl_b32 s7, s7, 11
    s_lshl_b32 s71, s69, 9
    s_add_u32 s7, s7, s71
    s_add_u32 s7, s7, 131072
    v_lshl_add_u32 v24, v0, 3, s7
    v_add_u32 v25, 0x1000, v24
    v_add_u32 v26, 0x2000, v24
    v_add_u32 v27, 0x3000, v24
    s_lshl_b32 s7, s4, 2
    s_add_u32 s7, s7, s69
    s_lshl_b32 s7, s7, 9
    s_add_u32 s7, s7, 98304
    v_and_b32 v22, 31, v0
    v_lshl_add_u32 v22, v22, 4, s7
    s_lshl_b32 s7, s67, 10
    s_lshl_b32 s71, s66, 9
    s_add_u32 s7, s7, s71
    v_lshl_add_u32 v23, v0, 3, s7
    s_lshl_b32 s7, s3, 7
    v_lshl_add_u32 v21, v28, 5, s7
    s_lshl_b32 s7, s3, 9
    v_lshl_add_u32 v20, v0, 5, s7
    s_waitcnt lgkmcnt(0)
    v_perm_b32 v32, v132, v128, s14
    v_perm_b32 v33, v140, v136, s14
    v_perm_b32 v34, v148, v144, s14
    v_perm_b32 v35, v156, v152, s14
    v_perm_b32 v36, v132, v128, s15
    v_perm_b32 v37, v140, v136, s15
    v_perm_b32 v38, v148, v144, s15
    v_perm_b32 v39, v156, v152, s15
    v_perm_b32 v40, v133, v129, s14
    v_perm_b32 v41, v141, v137, s14
    v_perm_b32 v42, v149, v145, s14
    v_perm_b32 v43, v157, v153, s14
    v_perm_b32 v44, v133, v129, s15
    v_perm_b32 v45, v141, v137, s15
    v_perm_b32 v46, v149, v145, s15
    v_perm_b32 v47, v157, v153, s15
    v_perm_b32 v48, v134, v130, s14
    v_perm_b32 v49, v142, v138, s14
    v_perm_b32 v50, v150, v146, s14
    v_perm_b32 v51, v158, v154, s14
    v_perm_b32 v52, v134, v130, s15
    v_perm_b32 v53, v142, v138, s15
    v_perm_b32 v54, v150, v146, s15
    v_perm_b32 v55, v158, v154, s15
    v_perm_b32 v56, v135, v131, s14
    v_perm_b32 v57, v143, v139, s14
    v_perm_b32 v58, v151, v147, s14
    v_perm_b32 v59, v159, v155, s14
    v_perm_b32 v60, v135, v131, s15
    v_perm_b32 v61, v143, v139, s15
    v_perm_b32 v62, v151, v147, s15
    v_perm_b32 v63, v159, v155, s15
    s_barrier
    s_mov_b32 s7, 0
    global_load_dwordx4 v[80:83], v22, s[8:9] sc1
    global_load_dwordx2 v[64:65], v24, s[8:9] offset:0 sc1
    global_load_dwordx2 v[66:67], v24, s[8:9] offset:2048 sc1
    global_load_dwordx2 v[68:69], v25, s[8:9] offset:0 sc1
    global_load_dwordx2 v[70:71], v25, s[8:9] offset:2048 sc1
    global_load_dwordx2 v[72:73], v26, s[8:9] offset:0 sc1
    global_load_dwordx2 v[74:75], v26, s[8:9] offset:2048 sc1
    global_load_dwordx2 v[76:77], v27, s[8:9] offset:0 sc1
    global_load_dwordx2 v[78:79], v27, s[8:9] offset:2048 sc1
L_ptop_8:
    s_waitcnt vmcnt(0)
    v_min3_u32 v2, v65, v67, v69
    v_min3_u32 v2, v2, v71, v73
    v_min3_u32 v2, v2, v75, v77
    v_min3_u32 v2, v2, v79, v81
    v_min_u32 v2, v2, v83
    v_max3_u32 v3, v65, v67, v69
    v_max3_u32 v3, v3, v71, v73
    v_max3_u32 v3, v3, v75, v77
    v_max3_u32 v3, v3, v79, v81
    v_max_u32 v3, v3, v83
    v_cmp_ne_u32 vcc, s6, v2
    v_cmp_ne_u32 s[12:13], s6, v3
    s_nop 0
    s_or_b64 s[12:13], s[12:13], vcc
    s_cbranch_scc1 L_pre_9
    v_mov_b32 v2, v80
    s_nop 1
    v_max_f32_dpp v2, v2, v2 row_ror:1 row_mask:0xf bank_mask:0xf
    s_nop 1
    v_max_f32_dpp v2, v2, v2 row_ror:2 row_mask:0xf bank_mask:0xf
    s_nop 1
    v_max_f32_dpp v2, v2, v2 row_ror:4 row_mask:0xf bank_mask:0xf
    s_nop 1
    v_max_f32_dpp v2, v2, v2 row_ror:8 row_mask:0xf bank_mask:0xf
    v_mov_b32 v3, v2
    s_nop 1
    v_permlane16_swap_b32 v2, v3
    v_max_f32 v2, v2, v3
    v_sub_f32 v4, v80, v2
    v_exp_f32 v4, v4
    s_nop 0
    v_mul_f32 v5, v4, v82
    s_nop 1
    v_add_f32_dpp v5, v5, v5 row_ror:1 row_mask:0xf bank_mask:0xf
    s_nop 1
    v_add_f32_dpp v5, v5, v5 row_ror:2 row_mask:0xf bank_mask:0xf
    s_nop 1
    v_add_f32_dpp v5, v5, v5 row_ror:4 row_mask:0xf bank_mask:0xf
    s_nop 1
    v_add_f32_dpp v5, v5, v5 row_ror:8 row_mask:0xf bank_mask:0xf
    v_mov_b32 v3, v5
    s_nop 1
    v_permlane16_swap_b32 v5, v3
    v_add_f32 v5, v5, v3
    v_and_b32 v65, 0xffff0000, v64
    v_lshlrev_b32 v64, 16, v64
    v_and_b32 v67, 0xffff0000, v66
    v_lshlrev_b32 v66, 16, v66
    v_and_b32 v69, 0xffff0000, v68
    v_lshlrev_b32 v68, 16, v68
    v_and_b32 v71, 0xffff0000, v70
    v_lshlrev_b32 v70, 16, v70
    v_and_b32 v73, 0xffff0000, v72
    v_lshlrev_b32 v72, 16, v72
    v_and_b32 v75, 0xffff0000, v74
    v_lshlrev_b32 v74, 16, v74
    v_and_b32 v77, 0xffff0000, v76
    v_lshlrev_b32 v76, 16, v76
    v_and_b32 v79, 0xffff0000, v78
    v_lshlrev_b32 v78, 16, v78
    v_rcp_f32 v5, v5
    s_nop 0
    v_mul_f32 v4, v4, v5
    s_add_u32 s7, s70, 0
    v_readlane_b32 s72, v4, s7
    s_add_u32 s7, s70, 1
    v_readlane_b32 s73, v4, s7
    s_add_u32 s7, s70, 2
    v_readlane_b32 s74, v4, s7
    s_add_u32 s7, s70, 3
    v_readlane_b32 s75, v4, s7
    s_add_u32 s7, s70, 4
    v_readlane_b32 s76, v4, s7
    s_add_u32 s7, s70, 5
    v_readlane_b32 s77, v4, s7
    s_add_u32 s7, s70, 6
    v_readlane_b32 s78, v4, s7
    s_add_u32 s7, s70, 7
    v_readlane_b32 s79, v4, s7
    v_mul_f32 v6, s72, v64
    v_mul_f32 v7, s72, v65
    v_mul_f32 v8, s73, v66
    v_mul_f32 v9, s73, v67
    v_fmac_f32 v6, s74, v68
    v_fmac_f32 v7, s74, v69
    v_fmac_f32 v8, s75, v70
    v_fmac_f32 v9, s75, v71
    v_fmac_f32 v6, s76, v72
    v_fmac_f32 v7, s76, v73
    v_fmac_f32 v8, s77, v74
    v_fmac_f32 v9, s77, v75
    v_fmac_f32 v6, s78, v76
    v_fmac_f32 v7, s78, v77
    v_fmac_f32 v8, s79, v78
    v_fmac_f32 v9, s79, v79
    s_branch L_pdone_7
L_pre_9:
    global_load_dwordx4 v[80:83], v22, s[8:9] sc1
    global_load_dwordx2 v[64:65], v24, s[8:9] offset:0 sc1
    global_load_dwordx2 v[66:67], v24, s[8:9] offset:2048 sc1
    global_load_dwordx2 v[68:69], v25, s[8:9] offset:0 sc1
    global_load_dwordx2 v[70:71], v25, s[8:9] offset:2048 sc1
    global_load_dwordx2 v[72:73], v26, s[8:9] offset:0 sc1
    global_load_dwordx2 v[74:75], v26, s[8:9] offset:2048 sc1
    global_load_dwordx2 v[76:77], v27, s[8:9] offset:0 sc1
    global_load_dwordx2 v[78:79], v27, s[8:9] offset:2048 sc1
    s_add_u32 s7, s7, 1
    s_cmp_lt_u32 s7, 200000
    s_cbranch_scc1 L_ptop_8
    s_endpgm
L_pdone_7:
    v_add_f32 v6, v6, v8
    v_add_f32 v7, v7, v9
    ds_write_b64 v23, v[6:7] offset:1024
    s_waitcnt lgkmcnt(0)
    s_barrier
    ds_read_b128 v[128:131], v21 offset:1024
    ds_read_b128 v[132:135], v21 offset:1040
    ds_read_b128 v[136:139], v21 offset:2048
    ds_read_b128 v[140:143], v21 offset:2064
    ds_read_b128 v[144:147], v21 offset:3072
    ds_read_b128 v[148:151], v21 offset:3088
    ds_read_b128 v[152:155], v21 offset:4096
    ds_read_b128 v[156:159], v21 offset:4112
    s_waitcnt lgkmcnt(4)
    v_add_f32 v128, v128, v136
    v_add_f32 v129, v129, v137
    v_add_f32 v130, v130, v138
    v_add_f32 v131, v131, v139
    v_add_f32 v132, v132, v140
    v_add_f32 v133, v133, v141
    v_add_f32 v134, v134, v142
    v_add_f32 v135, v135, v143
    s_waitcnt lgkmcnt(0)
    v_add_f32 v144, v144, v152
    v_add_f32 v145, v145, v153
    v_add_f32 v146, v146, v154
    v_add_f32 v147, v147, v155
    v_add_f32 v148, v148, v156
    v_add_f32 v149, v149, v157
    v_add_f32 v150, v150, v158
    v_add_f32 v151, v151, v159
    v_add_f32 v128, v128, v144
    v_add_f32 v129, v129, v145
    v_add_f32 v130, v130, v146
    v_add_f32 v131, v131, v147
    v_add_f32 v132, v132, v148
    v_add_f32 v133, v133, v149
    v_add_f32 v134, v134, v150
    v_add_f32 v135, v135, v151
    v_cvt_pk_bf16_f32 v16, v128, v129
    v_cvt_pk_bf16_f32 v17, v130, v131
    v_cvt_pk_bf16_f32 v18, v132, v133
    v_cvt_pk_bf16_f32 v19, v134, v135
    s_nop 1
    v_mfma_f32_16x16x32_bf16 v[128:131], v[16:19], v[32:35], 0
    v_mfma_f32_16x16x32_bf16 v[132:135], v[16:19], v[36:39], 0
    v_mfma_f32_16x16x32_bf16 v[136:139], v[16:19], v[40:43], 0
    v_mfma_f32_16x16x32_bf16 v[140:143], v[16:19], v[44:47], 0
    v_mfma_f32_16x16x32_bf16 v[144:147], v[16:19], v[48:51], 0
    v_mfma_f32_16x16x32_bf16 v[148:151], v[16:19], v[52:55], 0
    v_mfma_f32_16x16x32_bf16 v[152:155], v[16:19], v[56:59], 0
    v_mfma_f32_16x16x32_bf16 v[156:159], v[16:19], v[60:63], 0
    v_lshlrev_b32 v23, 3, v0
    s_lshl_b32 s7, s81, 9
    s_add_u32 s7, s7, 1179648
    v_add_u32 v22, s7, v23
    v_mov_b32 v3, s6
    v_add_u32 v20, 17664, v20
    s_mov_b64 exec, 0xffff
    ds_write2_b32 v20, v128, v132 offset0:0 offset1:1
    ds_write2_b32 v20, v136, v140 offset0:2 offset1:3
    ds_write2_b32 v20, v144, v148 offset0:4 offset1:5
    ds_write2_b32 v20, v152, v156 offset0:6 offset1:7
    s_mov_b64 exec, -1
    s_waitcnt lgkmcnt(0)
    s_barrier
    s_cmp_lg_u32 s3, 0
    s_cbranch_scc1 L_end
    ds_read_b64 v[128:129], v23 offset:17664
    ds_read_b64 v[130:131], v23 offset:18176
    ds_read_b64 v[132:133], v23 offset:18688
    ds_read_b64 v[134:135], v23 offset:19200
    ds_read_b64 v[136:137], v23 offset:19712
    ds_read_b64 v[138:139], v23 offset:20224
    ds_read_b64 v[140:141], v23 offset:20736
    ds_read_b64 v[142:143], v23 offset:21248
    s_waitcnt lgkmcnt(0)
    v_add_f32 v128, v128, v130
    v_add_f32 v129, v129, v131
    v_add_f32 v132, v132, v134
    v_add_f32 v133, v133, v135
    v_add_f32 v136, v136, v138
    v_add_f32 v137, v137, v139
    v_add_f32 v140, v140, v142
    v_add_f32 v141, v141, v143
    v_add_f32 v128, v128, v132
    v_add_f32 v129, v129, v133
    v_add_f32 v136, v136, v140
    v_add_f32 v137, v137, v141
    v_add_f32 v128, v128, v136
    v_add_f32 v129, v129, v137
    v_cvt_pk_bf16_f32 v2, v128, v129
    global_store_dwordx2 v22, v[2:3], s[8:9] offset:0 sc1
    s_endpgm
L_MLP:
    s_lshl_b32 s7, s3, 13
    s_add_u32 s7, s7, 22528
    v_add_u32 v24, s7, v1
    ds_read_b128 v[64:67], v24 offset:0
    ds_read_b128 v[68:71], v24 offset:1024
    ds_read_b128 v[72:75], v24 offset:2048
    ds_read_b128 v[76:79], v24 offset:3072
    ds_read_b128 v[80:83], v24 offset:4096
    ds_read_b128 v[84:87], v24 offset:5120
    ds_read_b128 v[88:91], v24 offset:6144
    ds_read_b128 v[92:95], v24 offset:7168
    v_add_u32 v24, 0x10000, v24
    ds_read_b128 v[96:99], v24 offset:0
    ds_read_b128 v[100:103], v24 offset:1024
    ds_read_b128 v[104:107], v24 offset:2048
    ds_read_b128 v[108:111], v24 offset:3072
    ds_read_b128 v[112:115], v24 offset:4096
    ds_read_b128 v[116:119], v24 offset:5120
    ds_read_b128 v[120:123], v24 offset:6144
    ds_read_b128 v[124:127], v24 offset:7168
    s_waitcnt lgkmcnt(8)
    v_perm_b32 v32, v68, v64, s14
    v_perm_b32 v33, v76, v72, s14
    v_perm_b32 v34, v84, v80, s14
    v_perm_b32 v35, v92, v88, s14
    v_perm_b32 v36, v68, v64, s15
    v_perm_b32 v37, v76, v72, s15
    v_perm_b32 v38, v84, v80, s15
    v_perm_b32 v39, v92, v88, s15
    v_perm_b32 v40, v69, v65, s14
    v_perm_b32 v41, v77, v73, s14
    v_perm_b32 v42, v85, v81, s14
    v_perm_b32 v43, v93, v89, s14
    v_perm_b32 v44, v69, v65, s15
    v_perm_b32 v45, v77, v73, s15
    v_perm_b32 v46, v85, v81, s15
    v_perm_b32 v47, v93, v89, s15
    v_perm_b32 v48, v70, v66, s14
    v_perm_b32 v49, v78, v74, s14
    v_perm_b32 v50, v86, v82, s14
    v_perm_b32 v51, v94, v90, s14
    v_perm_b32 v52, v70, v66, s15
    v_perm_b32 v53, v78, v74, s15
    v_perm_b32 v54, v86, v82, s15
    v_perm_b32 v55, v94, v90, s15
    v_perm_b32 v56, v71, v67, s14
    v_perm_b32 v57, v79, v75, s14
    v_perm_b32 v58, v87, v83, s14
    v_perm_b32 v59, v95, v91, s14
    v_perm_b32 v60, v71, v67, s15
    v_perm_b32 v61, v79, v75, s15
    v_perm_b32 v62, v87, v83, s15
    v_perm_b32 v63, v95, v91, s15
    s_waitcnt lgkmcnt(0)
    v_perm_b32 v64, v100, v96, s14
    v_perm_b32 v65, v108, v104, s14
    v_perm_b32 v66, v116, v112, s14
    v_perm_b32 v67, v124, v120, s14
    v_perm_b32 v68, v100, v96, s15
    v_perm_b32 v69, v108, v104, s15
    v_perm_b32 v70, v116, v112, s15
    v_perm_b32 v71, v124, v120, s15
    v_perm_b32 v72, v101, v97, s14
    v_perm_b32 v73, v109, v105, s14
    v_perm_b32 v74, v117, v113, s14
    v_perm_b32 v75, v125, v121, s14
    v_perm_b32 v76, v101, v97, s15
    v_perm_b32 v77, v109, v105, s15
    v_perm_b32 v78, v117, v113, s15
    v_perm_b32 v79, v125, v121, s15
    v_perm_b32 v80, v102, v98, s14
    v_perm_b32 v81, v110, v106, s14
    v_perm_b32 v82, v118, v114, s14
    v_perm_b32 v83, v126, v122, s14
    v_perm_b32 v84, v102, v98, s15
    v_perm_b32 v85, v110, v106, s15
    v_perm_b32 v86, v118, v114, s15
    v_perm_b32 v87, v126, v122, s15
    v_perm_b32 v88, v103, v99, s14
    v_perm_b32 v89, v111, v107, s14
    v_perm_b32 v90, v119, v115, s14
    v_perm_b32 v91, v127, v123, s14
    v_perm_b32 v92, v103, v99, s15
    v_perm_b32 v93, v111, v107, s15
    v_perm_b32 v94, v119, v115, s15
    v_perm_b32 v95, v127, v123, s15
    v_accvgpr_write_b32 a0, v64
    v_accvgpr_write_b32 a1, v65
    v_accvgpr_write_b32 a2, v66
    v_accvgpr_write_b32 a3, v67
    v_accvgpr_write_b32 a4, v68
    v_accvgpr_write_b32 a5, v69
    v_accvgpr_write_b32 a6, v70
    v_accvgpr_write_b32 a7, v71
    v_accvgpr_write_b32 a8, v72
    v_accvgpr_write_b32 a9, v73
    v_accvgpr_write_b32 a10, v74
    v_accvgpr_write_b32 a11, v75
    v_accvgpr_write_b32 a12, v76
    v_accvgpr_write_b32 a13, v77
    v_accvgpr_write_b32 a14, v78
    v_accvgpr_write_b32 a15, v79
    v_accvgpr_write_b32 a16, v80
    v_accvgpr_write_b32 a17, v81
    v_accvgpr_write_b32 a18, v82
    v_accvgpr_write_b32 a19, v83
    v_accvgpr_write_b32 a20, v84
    v_accvgpr_write_b32 a21, v85
    v_accvgpr_write_b32 a22, v86
    v_accvgpr_write_b32 a23, v87
    v_accvgpr_write_b32 a24, v88
    v_accvgpr_write_b32 a25, v89
    v_accvgpr_write_b32 a26, v90
    v_accvgpr_write_b32 a27, v91
    v_accvgpr_write_b32 a28, v92
    v_accvgpr_write_b32 a29, v93
    v_accvgpr_write_b32 a30, v94
    v_accvgpr_write_b32 a31, v95
    v_lshlrev_b32 v24, 5, v0
    v_add_u32 v24, 69632, v24
    v_add_u32 v25, 0x1000, v24
    s_lshl_b32 s7, s81, 7
    s_add_u32 s7, s7, 75776
    v_lshl_add_u32 v26, v29, 3, s7
    global_load_dwordx4 v[88:91], v1, s[16:17]
    s_mov_b32 s7, 0
    s_branch L_go_11
L_poll_10:
    s_add_u32 s7, s7, 1
    s_cmp_ge_u32 s7, 200000
    s_cbranch_scc1 L_end
L_go_11:
    global_load_dwordx4 v[64:67], v24, s[8:9] sc1
    global_load_dwordx4 v[68:71], v24, s[8:9] offset:16 sc1
    global_load_dwordx4 v[72:75], v24, s[8:9] offset:2048 sc1
    global_load_dwordx4 v[76:79], v24, s[8:9] offset:2064 sc1
    global_load_dwordx4 v[80:83], v25, s[8:9] sc1
    global_load_dwordx4 v[84:87], v25, s[8:9] offset:16 sc1
    v_min_u32 v27, 0x12ff8, v26
    global_load_dwordx2 v[92:93], v27, s[8:9] sc1
    s_waitcnt vmcnt(0)
    v_min3_u32 v94, v65, v67, v69
    v_min3_u32 v94, v94, v71, v73
    v_min3_u32 v94, v94, v75, v77
    v_min3_u32 v94, v94, v79, v81
    v_min3_u32 v94, v94, v83, v85
    v_min3_u32 v94, v94, v87, v93
    v_max3_u32 v95, v65, v67, v69
    v_max3_u32 v95, v95, v71, v73
    v_max3_u32 v95, v95, v75, v77
    v_max3_u32 v95, v95, v79, v81
    v_max3_u32 v95, v95, v83, v85
    v_max3_u32 v95, v95, v87, v93
    v_cmp_ne_u32 vcc, s6, v94
    v_cmp_ne_u32 s[12:13], s6, v95
    s_nop 0
    s_or_b64 s[12:13], s[12:13], vcc
    s_cbranch_scc1 L_poll_10
    v_lshlrev_b32 v128, 16, v88
    v_and_b32 v129, 0xffff0000, v88
    v_lshlrev_b32 v130, 16, v89
    v_and_b32 v131, 0xffff0000, v89
    v_lshlrev_b32 v132, 16, v90
    v_and_b32 v133, 0xffff0000, v90
    v_lshlrev_b32 v134, 16, v91
    v_and_b32 v135, 0xffff0000, v91
    v_lshlrev_b32 v136, 16, v64
    v_and_b32 v137, 0xffff0000, v64
    v_lshlrev_b32 v138, 16, v66
    v_and_b32 v139, 0xffff0000, v66
    v_lshlrev_b32 v140, 16, v68
    v_and_b32 v141, 0xffff0000, v68
    v_lshlrev_b32 v142, 16, v70
    v_and_b32 v143, 0xffff0000, v70
    v_lshlrev_b32 v144, 16, v72
    v_and_b32 v145, 0xffff0000, v72
    v_lshlrev_b32 v146, 16, v74
    v_and_b32 v147, 0xffff0000, v74
    v_lshlrev_b32 v148, 16, v76
    v_and_b32 v149, 0xffff0000, v76
    v_lshlrev_b32 v150, 16, v78
    v_and_b32 v151, 0xffff0000, v78
    v_lshlrev_b32 v152, 16, v80
    v_and_b32 v153, 0xffff0000, v80
    v_lshlrev_b32 v154, 16, v82
    v_and_b32 v155, 0xffff0000, v82
    v_lshlrev_b32 v156, 16, v84
    v_and_b32 v157, 0xffff0000, v84
    v_lshlrev_b32 v158, 16, v86
    v_and_b32 v159, 0xffff0000, v86
    v_add_f32 v152, 1.0, v152
    v_add_f32 v153, 1.0, v153
    v_add_f32 v154, 1.0, v154
    v_add_f32 v155, 1.0, v155
    v_add_f32 v156, 1.0, v156
    v_add_f32 v157, 1.0, v157
    v_add_f32 v158, 1.0, v158
    v_add_f32 v159, 1.0, v159
    v_mov_b32 v21, v92
    s_lshr_b32 s66, s3, 2
    s_and_b32 s67, s3, 3
    s_lshl_b32 s7, s66, 14
    s_lshl_b32 s68, s67, 9
    s_add_u32 s7, s7, s68
    s_add_u32 s7, s7, 1179648
    v_lshl_add_u32 v24, v0, 3, s7
    v_add_u32 v25, 0x1000, v24
    v_add_u32 v26, 0x2000, v24
    v_add_u32 v27, 0x3000, v24
    s_lshl_b32 s7, s66, 11
    s_add_u32 s7, s7, s68
    v_lshl_add_u32 v23, v0, 3, s7
    v_lshlrev_b32 v22, 5, v0
    s_lshl_b32 s7, s3, 10
    v_add_u32 v20, s7, v1
    v_and_b32 v9, 1, v0
    v_lshlrev_b32 v9, 2, v9
    v_add_u32 v9, v9, v28
    s_mul_i32 s7, s3, 1152
    v_lshl_add_u32 v10, v9, 4, s7
    s_lshl_b32 s7, s3, 7
    v_lshl_add_u32 v9, v9, 4, s7
    v_lshl_add_u32 v11, v0, 1, s7
    s_lshl_b32 s7, s3, 8
    v_add_u32 v12, s7, v22
    v_lshlrev_b32 v13, 2, v0
    s_lshl_b32 s7, s81, 11
    s_lshl_b32 s68, s3, 8
    s_add_u32 s7, s7, s68
    s_add_u32 s7, s7, 1245184
    v_add_u32 v14, s7, v22
    s_barrier
    s_mov_b32 s7, 0
    global_load_dwordx2 v[64:65], v24, s[8:9] offset:0 sc1
    global_load_dwordx2 v[66:67], v24, s[8:9] offset:2048 sc1
    global_load_dwordx2 v[68:69], v25, s[8:9] offset:0 sc1
    global_load_dwordx2 v[70:71], v25, s[8:9] offset:2048 sc1
    global_load_dwordx2 v[72:73], v26, s[8:9] offset:0 sc1
    global_load_dwordx2 v[74:75], v26, s[8:9] offset:2048 sc1
    global_load_dwordx2 v[76:77], v27, s[8:9] offset:0 sc1
    global_load_dwordx2 v[78:79], v27, s[8:9] offset:2048 sc1
L_ptop_13:
    s_waitcnt vmcnt(0)
    v_min3_u32 v2, v65, v67, v69
    v_min3_u32 v2, v2, v71, v73
    v_min3_u32 v2, v2, v75, v77
    v_min_u32 v2, v2, v79
    v_max3_u32 v3, v65, v67, v69
    v_max3_u32 v3, v3, v71, v73
    v_max3_u32 v3, v3, v75, v77
    v_max_u32 v3, v3, v79
    v_cmp_ne_u32 vcc, s6, v2
    v_cmp_ne_u32 s[12:13], s6, v3
    s_nop 0
    s_or_b64 s[12:13], s[12:13], vcc
    s_cbranch_scc1 L_pre_14
    v_and_b32 v65, 0xffff0000, v64
    v_lshlrev_b32 v64, 16, v64
    v_and_b32 v67, 0xffff0000, v66
    v_lshlrev_b32 v66, 16, v66
    v_and_b32 v69, 0xffff0000, v68
    v_lshlrev_b32 v68, 16, v68
    v_and_b32 v71, 0xffff0000, v70
    v_lshlrev_b32 v70, 16, v70
    v_and_b32 v73, 0xffff0000, v72
    v_lshlrev_b32 v72, 16, v72
    v_and_b32 v75, 0xffff0000, v74
    v_lshlrev_b32 v74, 16, v74
    v_and_b32 v77, 0xffff0000, v76
    v_lshlrev_b32 v76, 16, v76
    v_and_b32 v79, 0xffff0000, v78
    v_lshlrev_b32 v78, 16, v78
    v_add_f32 v64, v64, v66
    v_add_f32 v65, v65, v67
    v_add_f32 v68, v68, v70
    v_add_f32 v69, v69, v71
    v_add_f32 v72, v72, v74
    v_add_f32 v73, v73, v75
    v_add_f32 v76, v76, v78
    v_add_f32 v77, v77, v79
    v_add_f32 v64, v64, v68
    v_add_f32 v65, v65, v69
    v_add_f32 v72, v72, v76
    v_add_f32 v73, v73, v77
    v_add_f32 v2, v64, v72
    v_add_f32 v3, v65, v73
    s_branch L_pdone_12
L_pre_14:
    global_load_dwordx2 v[64:65], v24, s[8:9] offset:0 sc1
    global_load_dwordx2 v[66:67], v24, s[8:9] offset:2048 sc1
    global_load_dwordx2 v[68:69], v25, s[8:9] offset:0 sc1
    global_load_dwordx2 v[70:71], v25, s[8:9] offset:2048 sc1
    global_load_dwordx2 v[72:73], v26, s[8:9] offset:0 sc1
    global_load_dwordx2 v[74:75], v26, s[8:9] offset:2048 sc1
    global_load_dwordx2 v[76:77], v27, s[8:9] offset:0 sc1
    global_load_dwordx2 v[78:79], v27, s[8:9] offset:2048 sc1
    s_add_u32 s7, s7, 1
    s_cmp_lt_u32 s7, 200000
    s_cbranch_scc1 L_ptop_13
    s_endpgm
L_pdone_12:
    ds_write_b64 v23, v[2:3] offset:1024
    s_waitcnt lgkmcnt(0)
    s_barrier
    ds_read_b128 v[112:115], v22 offset:1024
    ds_read_b128 v[120:123], v22 offset:3072
    ds_read_b128 v[116:119], v22 offset:1040
    ds_read_b128 v[124:127], v22 offset:3088
    s_waitcnt lgkmcnt(2)
    v_add_f32 v112, v112, v120
    v_add_f32 v113, v113, v121
    v_add_f32 v114, v114, v122
    v_add_f32 v115, v115, v123
    s_waitcnt lgkmcnt(0)
    v_add_f32 v116, v116, v124
    v_add_f32 v117, v117, v125
    v_add_f32 v118, v118, v126
    v_add_f32 v119, v119, v127
    v_fma_f32 v112, v136, v112, v128
    v_fma_f32 v113, v137, v113, v129
    v_fma_f32 v114, v138, v114, v130
    v_fma_f32 v115, v139, v115, v131
    v_fma_f32 v116, v140, v116, v132
    v_fma_f32 v117, v141, v117, v133
    v_fma_f32 v118, v142, v118, v134
    v_fma_f32 v119, v143, v119, v135
    v_add_f32 v120, v112, v113
    v_add_f32 v121, v114, v115
    v_add_f32 v122, v116, v117
    v_add_f32 v123, v118, v119
    v_add_f32 v120, v120, v121
    v_add_f32 v122, v122, v123
    v_add_f32 v2, v120, v122
    s_cmp_lg_u32 s3, 0
    s_cbranch_scc1 L_MLP_nox2
    ds_write_b128 v22, v[112:115] offset:17664
    ds_write_b128 v22, v[116:119] offset:17680
L_MLP_nox2:
    v_add_f32_dpp v2, v2, v2 row_ror:1 row_mask:0xf bank_mask:0xf
    s_nop 1
    v_add_f32_dpp v2, v2, v2 row_ror:2 row_mask:0xf bank_mask:0xf
    s_nop 1
    v_add_f32_dpp v2, v2, v2 row_ror:4 row_mask:0xf bank_mask:0xf
    s_nop 1
    v_add_f32_dpp v2, v2, v2 row_ror:8 row_mask:0xf bank_mask:0xf
    v_mov_b32 v3, v2
    s_nop 1
    v_permlane16_swap_b32 v2, v3
    v_add_f32 v2, v2, v3
    v_mov_b32 v3, v2
    s_nop 1
    v_permlane32_swap_b32 v2, v3
    v_add_f32 v2, v2, v3
    v_mul_f32 v2, 0x3b000000, v2
    v_sub_f32 v120, v112, v2
    v_sub_f32 v121, v113, v2
    v_sub_f32 v122, v114, v2
    v_sub_f32 v123, v115, v2
    v_sub_f32 v124, v116, v2
    v_sub_f32 v125, v117, v2
    v_sub_f32 v126, v118, v2
    v_sub_f32 v127, v119, v2
    v_mul_f32 v4, v120, v120
    v_mul_f32 v5, v121, v121
    v_fmac_f32 v4, v122, v122
    v_fmac_f32 v5, v123, v123
    v_fmac_f32 v4, v124, v124
    v_fmac_f32 v5, v125, v125
    v_fmac_f32 v4, v126, v126
    v_fmac_f32 v5, v127, v127
    v_add_f32 v4, v4, v5
    v_mul_f32 v120, v120, v152
    v_mul_f32 v121, v121, v153
    v_mul_f32 v122, v122, v154
    v_mul_f32 v123, v123, v155
    v_mul_f32 v124, v124, v156
    v_mul_f32 v125, v125, v157
    v_mul_f32 v126, v126, v158
    v_mul_f32 v127, v127, v159
    v_add_f32_dpp v4, v4, v4 row_ror:1 row_mask:0xf bank_mask:0xf
    s_nop 1
    v_add_f32_dpp v4, v4, v4 row_ror:2 row_mask:0xf bank_mask:0xf
    s_nop 1
    v_add_f32_dpp v4, v4, v4 row_ror:4 row_mask:0xf bank_mask:0xf
    s_nop 1
    v_add_f32_dpp v4, v4, v4 row_ror:8 row_mask:0xf bank_mask:0xf
    v_mov_b32 v3, v4
    s_nop 1
    v_permlane16_swap_b32 v4, v3
    v_add_f32 v4, v4, v3
    v_mov_b32 v3, v4
    s_nop 1
    v_permlane32_swap_b32 v4, v3
    v_add_f32 v4, v4, v3
    v_mov_b32 v5, 0x3727c5ac
    v_fmac_f32 v5, 0x3b000000, v4
    v_rsq_f32 v5, v5
    s_nop 0
    v_fma_f32 v120, v120, v5, v144
    v_fma_f32 v121, v121, v5, v145
    v_fma_f32 v122, v122, v5, v146
    v_fma_f32 v123, v123, v5, v147
    v_fma_f32 v124, v124, v5, v148
    v_fma_f32 v125, v125, v5, v149
    v_fma_f32 v126, v126, v5, v150
    v_fma_f32 v127, v127, v5, v151
    v_cvt_pk_bf16_f32 v4, v120, v121
    v_cvt_pk_bf16_f32 v5, v122, v123
    v_cvt_pk_bf16_f32 v6, v124, v125
    v_cvt_pk_bf16_f32 v7, v126, v127
    ds_write_b128 v20, v[4:7] offset:5120
    s_waitcnt lgkmcnt(0)
    ds_read_b128 v[16:19], v10 offset:5120
    s_waitcnt lgkmcnt(0)
    v_mfma_f32_16x16x32_bf16 v[128:131], v[16:19], v[32:35], 0
    v_mfma_f32_16x16x32_bf16 v[132:135], v[16:19], v[36:39], 0
    v_mfma_f32_16x16x32_bf16 v[136:139], v[16:19], v[40:43], 0
    v_mfma_f32_16x16x32_bf16 v[140:143], v[16:19], v[44:47], 0
    v_mfma_f32_16x16x32_bf16 v[144:147], v[16:19], v[48:51], 0
    v_mfma_f32_16x16x32_bf16 v[148:151], v[16:19], v[52:55], 0
    v_mfma_f32_16x16x32_bf16 v[152:155], v[16:19], v[56:59], 0
    v_mfma_f32_16x16x32_bf16 v[156:159], v[16:19], v[60:63], 0
    s_nop 0
    v_add_f32_dpp v112, v129, v128 row_ror:8 row_mask:0xf bank_mask:0xf
    v_add_f32_dpp v113, v133, v132 row_ror:8 row_mask:0xf bank_mask:0xf
    v_add_f32_dpp v114, v137, v136 row_ror:8 row_mask:0xf bank_mask:0xf
    v_add_f32_dpp v115, v141, v140 row_ror:8 row_mask:0xf bank_mask:0xf
    v_add_f32_dpp v116, v145, v144 row_ror:8 row_mask:0xf bank_mask:0xf
    v_add_f32_dpp v117, v149, v148 row_ror:8 row_mask:0xf bank_mask:0xf
    v_add_f32_dpp v118, v153, v152 row_ror:8 row_mask:0xf bank_mask:0xf
    v_add_f32_dpp v119, v157, v156 row_ror:8 row_mask:0xf bank_mask:0xf
    s_mov_b64 exec, 0xff
    ds_write_b128 v12, v[112:115] offset:13312
    ds_write_b128 v12, v[116:119] offset:13328
    s_mov_b64 exec, -1
    s_waitcnt lgkmcnt(0)
    s_barrier
    ds_read_b32 v120, v13 offset:13312
    ds_read_b32 v121, v13 offset:13568
    ds_read_b32 v122, v13 offset:13824
    ds_read_b32 v123, v13 offset:14080
    ds_read_b32 v124, v13 offset:14336
    ds_read_b32 v125, v13 offset:14592
    ds_read_b32 v126, v13 offset:14848
    ds_read_b32 v127, v13 offset:15104
    s_waitcnt lgkmcnt(0)
    v_add_f32 v120, v120, v121
    v_add_f32 v122, v122, v123
    v_add_f32 v124, v124, v125
    v_add_f32 v126, v126, v127
    v_add_f32 v120, v120, v122
    v_add_f32 v124, v124, v126
    v_add_f32 v120, v120, v124
    v_mul_f32 v121, s58, v120
    v_exp_f32 v121, v121
    s_nop 0
    v_add_f32 v121, 1.0, v121
    v_rcp_f32 v121, v121
    s_nop 0
    v_mul_f32 v120, v120, v121
    v_cvt_pk_bf16_f32 v120, v120, v120
    ds_write_b16 v11, v120 offset:15360
    v_mov_b32 v121, s6
    v_mov_b32 v123, s6
    v_mov_b32 v125, s6
    v_mov_b32 v127, s6
    s_waitcnt lgkmcnt(0)
    ds_read_b128 v[16:19], v9 offset:15360
    s_waitcnt lgkmcnt(0)
    v_mfma_f32_16x16x32_bf16 v[128:131], v[16:19], a[0:3], 0
    v_mfma_f32_16x16x32_bf16 v[132:135], v[16:19], a[4:7], 0
    v_mfma_f32_16x16x32_bf16 v[136:139], v[16:19], a[8:11], 0
    v_mfma_f32_16x16x32_bf16 v[140:143], v[16:19], a[12:15], 0
    v_mfma_f32_16x16x32_bf16 v[144:147], v[16:19], a[16:19], 0
    v_mfma_f32_16x16x32_bf16 v[148:151], v[16:19], a[20:23], 0
    v_mfma_f32_16x16x32_bf16 v[152:155], v[16:19], a[24:27], 0
    v_mfma_f32_16x16x32_bf16 v[156:159], v[16:19], a[28:31], 0
    s_nop 0
    v_add_f32_dpp v112, v129, v128 row_ror:8 row_mask:0xf bank_mask:0xf
    v_add_f32_dpp v113, v133, v132 row_ror:8 row_mask:0xf bank_mask:0xf
    v_add_f32_dpp v114, v137, v136 row_ror:8 row_mask:0xf bank_mask:0xf
    v_add_f32_dpp v115, v141, v140 row_ror:8 row_mask:0xf bank_mask:0xf
    v_add_f32_dpp v116, v145, v144 row_ror:8 row_mask:0xf bank_mask:0xf
    v_add_f32_dpp v117, v149, v148 row_ror:8 row_mask:0xf bank_mask:0xf
    v_add_f32_dpp v118, v153, v152 row_ror:8 row_mask:0xf bank_mask:0xf
    v_add_f32_dpp v119, v157, v156 row_ror:8 row_mask:0xf bank_mask:0xf
    v_cvt_pk_bf16_f32 v120, v112, v113
    v_cvt_pk_bf16_f32 v122, v114, v115
    v_cvt_pk_bf16_f32 v124, v116, v117
    v_cvt_pk_bf16_f32 v126, v118, v119
    s_mov_b64 exec, 0xff
    global_store_dwordx4 v14, v[120:123], s[8:9] offset:0 sc1
    global_store_dwordx4 v14, v[124:127], s[8:9] offset:16 sc1
    s_mov_b64 exec, -1
    s_cmp_lg_u32 s3, 0
    s_cbranch_scc1 L_end
    s_cmp_ge_u32 s81, 16
    s_cbranch_scc1 L_end
    s_lshl_b32 s7, s81, 7
    v_lshl_add_u32 v22, v29, 3, s7
    ds_read_b64 v[112:113], v22 offset:17664
    v_lshl_add_u32 v24, v28, 11, v22
    v_add_u32 v24, 1245184, v24
    v_add_u32 v115, 8192, v24
    v_add_u32 v116, 16384, v24
    v_add_u32 v117, 24576, v24
    v_add_u32 v118, 32768, v24
    v_add_u32 v119, 40960, v24
    v_add_u32 v120, 49152, v24
    v_lshlrev_b32 v4, 16, v21
    v_and_b32 v5, 0xffff0000, v21
    v_lshrrev_b32 v22, 1, v22
    s_mov_b32 s7, 0
    global_load_dwordx2 v[64:65], v24, s[8:9] sc1
    global_load_dwordx2 v[66:67], v115, s[8:9] sc1
    global_load_dwordx2 v[68:69], v116, s[8:9] sc1
    global_load_dwordx2 v[70:71], v117, s[8:9] sc1
    global_load_dwordx2 v[72:73], v118, s[8:9] sc1
    global_load_dwordx2 v[74:75], v119, s[8:9] sc1
    global_load_dwordx2 v[76:77], v120, s[8:9] sc1
L_ptop_16:
    s_waitcnt vmcnt(0)
    v_min3_u32 v2, v65, v67, v69
    v_min3_u32 v2, v2, v71, v73
    v_min3_u32 v2, v2, v75, v77
    v_max3_u32 v3, v65, v67, v69
    v_max3_u32 v3, v3, v71, v73
    v_max3_u32 v3, v3, v75, v77
    v_cmp_ne_u32 vcc, s6, v2
    v_cmp_ne_u32 s[12:13], s6, v3
    s_nop 0
    s_or_b64 s[12:13], s[12:13], vcc
    s_cbranch_scc1 L_pre_17
    v_and_b32 v65, 0xffff0000, v64
    v_lshlrev_b32 v64, 16, v64
    v_and_b32 v67, 0xffff0000, v66
    v_lshlrev_b32 v66, 16, v66
    v_and_b32 v69, 0xffff0000, v68
    v_lshlrev_b32 v68, 16, v68
    v_and_b32 v71, 0xffff0000, v70
    v_lshlrev_b32 v70, 16, v70
    v_and_b32 v73, 0xffff0000, v72
    v_lshlrev_b32 v72, 16, v72
    v_and_b32 v75, 0xffff0000, v74
    v_lshlrev_b32 v74, 16, v74
    v_and_b32 v77, 0xffff0000, v76
    v_lshlrev_b32 v76, 16, v76
    v_add_f32 v64, v64, v66
    v_add_f32 v65, v65, v67
    v_add_f32 v68, v68, v70
    v_add_f32 v69, v69, v71
    v_add_f32 v72, v72, v74
    v_add_f32 v73, v73, v75
    v_add_f32 v64, v64, v68
    v_add_f32 v65, v65, v69
    v_add_f32 v72, v72, v76
    v_add_f32 v73, v73, v77
    v_add_f32 v2, v64, v72
    v_add_f32 v3, v65, v73
    s_branch L_pdone_15
L_pre_17:
    global_load_dwordx2 v[64:65], v24, s[8:9] sc1
    global_load_dwordx2 v[66:67], v115, s[8:9] sc1
    global_load_dwordx2 v[68:69], v116, s[8:9] sc1
    global_load_dwordx2 v[70:71], v117, s[8:9] sc1
    global_load_dwordx2 v[72:73], v118, s[8:9] sc1
    global_load_dwordx2 v[74:75], v119, s[8:9] sc1
    global_load_dwordx2 v[76:77], v120, s[8:9] sc1
    s_add_u32 s7, s7, 1
    s_cmp_lt_u32 s7, 200000
    s_cbranch_scc1 L_ptop_16
    s_endpgm
L_pdone_15:
    v_mov_b32 v6, v2
    v_mov_b32 v7, v3
    s_nop 0
    v_permlane16_swap_b32 v2, v6
    v_permlane16_swap_b32 v3, v7
    v_add_f32 v2, v2, v6
    v_add_f32 v3, v3, v7
    v_mov_b32 v6, v2
    v_mov_b32 v7, v3
    s_nop 0
    v_permlane32_swap_b32 v2, v6
    v_permlane32_swap_b32 v3, v7
    v_add_f32 v2, v2, v6
    v_add_f32 v3, v3, v7
    s_waitcnt lgkmcnt(0)
    v_fma_f32 v2, v4, v2, v112
    v_fma_f32 v3, v5, v3, v113
    v_cvt_pk_bf16_f32 v2, v2, v3
    s_mov_b64 exec, 0xffff
    global_store_dword v22, v2, s[36:37]
    s_mov_b64 exec, -1
    s_cmp_lg_u32 s81, 0
    s_cbranch_scc1 L_end2
    v_mov_b32 v22, 0
    s_add_u32 s7, s86, 1
    v_mov_b32 v23, s7
    s_mov_b64 exec, 1
    global_store_dword v22, v23, s[8:9]
    s_mov_b64 exec, -1
L_end2:
    s_endpgm
L_roleA:
    s_mov_b32 s80, 1
    s_mul_i32 s81, s4, 6
    s_add_u32 s81, s81, s5
    s_mov_b32 s48, s34
    s_mov_b32 s49, s35
    s_mov_b32 s50, 3145728
    s_mov_b32 s51, 0x20000
    s_movk_i32 s7, 6144
    v_mul_lo_u32 v112, v27, s7
    v_add_u32 v112, v112, v26
    s_mul_i32 s66, s3, 393216
    s_lshl_b32 s7, s81, 7
    s_add_u32 s66, s66, s7
    s_lshl_b32 s7, s3, 6
    v_add_u32 v113, s7, v25
    v_lshlrev_b32 v113, 1, v113
    global_load_dwordx4 v[96:99], v113, s[32:33]
    buffer_load_dwordx4 v[64:67], v112, s[48:51], s66 offen nt
    s_add_u32 s66, s66, 6144
    buffer_load_dwordx4 v[68:71], v112, s[48:51], s66 offen nt
    s_add_u32 s66, s66, 6144
    buffer_load_dwordx4 v[72:75], v112, s[48:51], s66 offen nt
    s_add_u32 s66, s66, 6144
    buffer_load_dwordx4 v[76:79], v112, s[48:51], s66 offen nt
    s_add_u32 s66, s66, 6144
    buffer_load_dwordx4 v[80:83], v112, s[48:51], s66 offen nt
    s_add_u32 s66, s66, 6144
    buffer_load_dwordx4 v[84:87], v112, s[48:51], s66 offen nt
    s_add_u32 s66, s66, 6144
    buffer_load_dwordx4 v[88:91], v112, s[48:51], s66 offen nt
    s_add_u32 s66, s66, 6144
    buffer_load_dwordx4 v[92:95], v112, s[48:51], s66 offen nt
    s_or_b32 s7, s81, s3
    s_cmp_lg_u32 s7, 0
    s_cbranch_scc1 L_A_nozero
    s_mov_b32 s7, 4352
    v_mul_lo_u32 v114, v0, s7
    v_add_u32 v114, 4194304, v114
    global_store_dword v114, v10, s[8:9] sc1
    s_waitcnt vmcnt(9)
    s_branch L_A_go
L_A_nozero:
    s_waitcnt vmcnt(8)
L_A_go:
    v_lshlrev_b32 v104, 16, v96
    v_and_b32 v105, 0xffff0000, v96
    v_lshlrev_b32 v106, 16, v97
    v_and_b32 v107, 0xffff0000, v97
    v_lshlrev_b32 v108, 16, v98
    v_and_b32 v109, 0xffff0000, v98
    v_lshlrev_b32 v110, 16, v99
    v_and_b32 v111, 0xffff0000, v99
    v_mul_f32 v112, s58, v104
    v_mul_f32 v113, s58, v105
    v_mul_f32 v114, s58, v106
    v_mul_f32 v115, s58, v107
    v_mul_f32 v116, s58, v108
    v_mul_f32 v117, s58, v109
    v_mul_f32 v118, s58, v110
    v_mul_f32 v119, s58, v111
    v_exp_f32 v112, v112
    v_exp_f32 v113, v113
    v_exp_f32 v114, v114
    v_exp_f32 v115, v115
    v_exp_f32 v116, v116
    v_exp_f32 v117, v117
    v_exp_f32 v118, v118
    v_exp_f32 v119, v119
    v_add_f32 v112, 1.0, v112
    v_add_f32 v113, 1.0, v113
    v_add_f32 v114, 1.0, v114
    v_add_f32 v115, 1.0, v115
    v_add_f32 v116, 1.0, v116
    v_add_f32 v117, 1.0, v117
    v_add_f32 v118, 1.0, v118
    v_add_f32 v119, 1.0, v119
    v_rcp_f32 v112, v112
    v_rcp_f32 v113, v113
    v_rcp_f32 v114, v114
    v_rcp_f32 v115, v115
    v_rcp_f32 v116, v116
    v_rcp_f32 v117, v117
    v_rcp_f32 v118, v118
    v_rcp_f32 v119, v119
    v_mul_f32 v104, v104, v112
    v_mul_f32 v105, v105, v113
    v_mul_f32 v106, v106, v114
    v_mul_f32 v107, v107, v115
    v_mul_f32 v108, v108, v116
    v_mul_f32 v109, v109, v117
    v_mul_f32 v110, v110, v118
    v_mul_f32 v111, v111, v119
    v_cvt_pk_bf16_f32 v16, v104, v105
    v_cvt_pk_bf16_f32 v17, v106, v107
    v_cvt_pk_bf16_f32 v18, v108, v109
    v_cvt_pk_bf16_f32 v19, v110, v111
    s_waitcnt vmcnt(0) lgkmcnt(0)
    s_mul_i32 s6, s86, 0x9e3779b1
    s_add_u32 s6, s6, 0x7f4a7c15
    v_perm_b32 v96, v68, v64, s14
    v_perm_b32 v97, v76, v72, s14
    v_perm_b32 v98, v84, v80, s14
    v_perm_b32 v99, v92, v88, s14
    v_perm_b32 v100, v68, v64, s15
    v_perm_b32 v101, v76, v72, s15
    v_perm_b32 v102, v84, v80, s15
    v_perm_b32 v103, v92, v88, s15
    v_perm_b32 v104, v69, v65, s14
    v_perm_b32 v105, v77, v73, s14
    v_perm_b32 v106, v85, v81, s14
    v_perm_b32 v107, v93, v89, s14
    v_mfma_f32_16x16x32_bf16 v[32:35], v[16:19], v[96:99], 0
    v_perm_b32 v96, v69, v65, s15
    v_perm_b32 v97, v77, v73, s15
    v_perm_b32 v98, v85, v81, s15
    v_perm_b32 v99, v93, v89, s15
    v_mfma_f32_16x16x32_bf16 v[36:39], v[16:19], v[100:103], 0
    v_perm_b32 v100, v70, v66, s14
    v_perm_b32 v101, v78, v74, s14
    v_perm_b32 v102, v86, v82, s14
    v_perm_b32 v103, v94, v90, s14
    v_mfma_f32_16x16x32_bf16 v[40:43], v[16:19], v[104:107], 0
    v_perm_b32 v104, v70, v66, s15
    v_perm_b32 v105, v78, v74, s15
    v_perm_b32 v106, v86, v82, s15
    v_perm_b32 v107, v94, v90, s15
    v_mfma_f32_16x16x32_bf16 v[44:47], v[16:19], v[96:99], 0
    v_perm_b32 v96, v71, v67, s14
    v_perm_b32 v97, v79, v75, s14
    v_perm_b32 v98, v87, v83, s14
    v_perm_b32 v99, v95, v91, s14
    v_mfma_f32_16x16x32_bf16 v[48:51], v[16:19], v[100:103], 0
    v_perm_b32 v100, v71, v67, s15
    v_perm_b32 v101, v79, v75, s15
    v_perm_b32 v102, v87, v83, s15
    v_perm_b32 v103, v95, v91, s15
    v_mfma_f32_16x16x32_bf16 v[52:55], v[16:19], v[104:107], 0
    v_mfma_f32_16x16x32_bf16 v[56:59], v[16:19], v[96:99], 0
    v_mfma_f32_16x16x32_bf16 v[60:63], v[16:19], v[100:103], 0
    v_add_f32_dpp v104, v33, v32 row_ror:8 row_mask:0xf bank_mask:0xf
    v_add_f32_dpp v105, v37, v36 row_ror:8 row_mask:0xf bank_mask:0xf
    v_add_f32_dpp v106, v41, v40 row_ror:8 row_mask:0xf bank_mask:0xf
    v_add_f32_dpp v107, v45, v44 row_ror:8 row_mask:0xf bank_mask:0xf
    v_add_f32_dpp v108, v49, v48 row_ror:8 row_mask:0xf bank_mask:0xf
    s_nop 0
    v_add_f32_dpp v109, v53, v52 row_ror:8 row_mask:0xf bank_mask:0xf
    v_add_f32_dpp v110, v57, v56 row_ror:8 row_mask:0xf bank_mask:0xf
    v_add_f32_dpp v111, v61, v60 row_ror:8 row_mask:0xf bank_mask:0xf
    v_lshlrev_b32 v112, 5, v0
    s_lshl_b32 s7, s3, 8
    v_add_u32 v112, s7, v112
    s_lshl_b32 s7, s3, 2
    v_mov_b32 v113, s7
    v_mov_b32 v35, s6
    s_mov_b64 exec, 0xff
    ds_write_b128 v112, v[104:107] offset:1024
    ds_write_b128 v112, v[108:111] offset:1040
    s_waitcnt lgkmcnt(0)
    s_mov_b64 exec, -1
    s_barrier
    s_cmp_lg_u32 s3, 0
    s_cbranch_scc1 L_common
    v_lshlrev_b32 v112, 3, v0
    s_lshl_b32 s7, s81, 8
    s_add_u32 s7, s7, 65536
    v_add_u32 v113, s7, v112
    ds_read_b64 v[36:37], v112 offset:1024
    ds_read_b64 v[38:39], v112 offset:1280
    ds_read_b64 v[40:41], v112 offset:1536
    ds_read_b64 v[42:43], v112 offset:1792
    ds_read_b64 v[44:45], v112 offset:2048
    ds_read_b64 v[46:47], v112 offset:2304
    ds_read_b64 v[48:49], v112 offset:2560
    ds_read_b64 v[50:51], v112 offset:2816
    s_waitcnt lgkmcnt(0)
    v_add_f32 v36, v36, v38
    v_add_f32 v37, v37, v39
    v_add_f32 v40, v40, v42
    v_add_f32 v41, v41, v43
    v_add_f32 v44, v44, v46
    v_add_f32 v45, v45, v47
    v_add_f32 v48, v48, v50
    v_add_f32 v49, v49, v51
    v_add_f32 v36, v36, v40
    v_add_f32 v37, v37, v41
    v_add_f32 v44, v44, v48
    v_add_f32 v45, v45, v49
    v_add_f32 v36, v36, v44
    v_add_f32 v37, v37, v45
    v_cvt_pk_bf16_f32 v34, v36, v37
    s_waitcnt vmcnt(0)
    s_mov_b64 exec, 0xffffffff
    global_store_dwordx2 v113, v[34:35], s[8:9] sc1
    s_mov_b64 exec, -1
    s_branch L_common
L_roleB:
    s_mov_b32 s80, 2
    s_lshl_b32 s81, s4, 3
    s_add_u32 s81, s81, s5
    s_sub_u32 s81, s81, 6
    s_cmp_ge_u32 s3, 4
    s_cbranch_scc1 L_common0
    s_mov_b32 s48, s22
    s_mov_b32 s49, s23
    s_mov_b32 s50, 4194304
    s_mov_b32 s51, 0x20000
    v_lshlrev_b32 v23, 13, v27
    v_add_u32 v23, v23, v26
    s_lshl_b32 s66, s3, 20
    s_lshl_b32 s7, s81, 7
    s_add_u32 s66, s66, s7
    v_and_b32 v24, 31, v0
    s_lshl_b32 s7, s3, 8
    v_lshl_add_u32 v26, v24, 3, s7
    global_load_dwordx4 v[32:35], v1, s[16:17]
    global_load_dwordx2 v[36:37], v26, s[16:17]
    buffer_load_dwordx4 v[64:67], v23, s[48:51], s66 offen nt
    s_add_u32 s66, s66, 8192
    buffer_load_dwordx4 v[68:71], v23, s[48:51], s66 offen nt
    s_add_u32 s66, s66, 8192
    buffer_load_dwordx4 v[72:75], v23, s[48:51], s66 offen nt
    s_add_u32 s66, s66, 8192
    buffer_load_dwordx4 v[76:79], v23, s[48:51], s66 offen nt
    s_add_u32 s66, s66, 8192
    buffer_load_dwordx4 v[80:83], v23, s[48:51], s66 offen nt
    s_add_u32 s66, s66, 8192
    buffer_load_dwordx4 v[84:87], v23, s[48:51], s66 offen nt
    s_add_u32 s66, s66, 8192
    buffer_load_dwordx4 v[88:91], v23, s[48:51], s66 offen nt
    s_add_u32 s66, s66, 8192
    buffer_load_dwordx4 v[92:95], v23, s[48:51], s66 offen nt
    s_add_u32 s66, s66, 466944
    buffer_load_dwordx4 v[96:99], v23, s[48:51], s66 offen nt
    s_add_u32 s66, s66, 8192
    buffer_load_dwordx4 v[100:103], v23, s[48:51], s66 offen nt
    s_add_u32 s66, s66, 8192
    buffer_load_dwordx4 v[104:107], v23, s[48:51], s66 offen nt
    s_add_u32 s66, s66, 8192
    buffer_load_dwordx4 v[108:111], v23, s[48:51], s66 offen nt
    s_add_u32 s66, s66, 8192
    buffer_load_dwordx4 v[112:115], v23, s[48:51], s66 offen nt
    s_add_u32 s66, s66, 8192
    buffer_load_dwordx4 v[116:119], v23, s[48:51], s66 offen nt
    s_add_u32 s66, s66, 8192
    buffer_load_dwordx4 v[120:123], v23, s[48:51], s66 offen nt
    s_add_u32 s66, s66, 8192
    buffer_load_dwordx4 v[124:127], v23, s[48:51], s66 offen nt
    v_lshrrev_b32 v27, 5, v0
    v_lshlrev_b32 v27, 11, v27
    v_lshl_add_u32 v27, v26, 1, v27
    v_add_u32 v27, 65536, v27
    s_waitcnt vmcnt(16)
    v_lshlrev_b32 v44, 16, v32
    v_and_b32 v45, 0xffff0000, v32
    v_lshlrev_b32 v46, 16, v33
    v_and_b32 v47, 0xffff0000, v33
    v_lshlrev_b32 v48, 16, v34
    v_and_b32 v49, 0xffff0000, v34
    v_lshlrev_b32 v50, 16, v35
    v_and_b32 v51, 0xffff0000, v35
    v_add_f32 v60, v44, v45
    v_add_f32 v60, v60, v46
    v_add_f32 v60, v60, v47
    v_add_f32 v60, v60, v48
    v_add_f32 v60, v60, v49
    v_add_f32 v60, v60, v50
    v_add_f32 v60, v60, v51
    s_nop 1
    v_add_f32_dpp v60, v60, v60 row_ror:1 row_mask:0xf bank_mask:0xf
    s_nop 1
    v_add_f32_dpp v60, v60, v60 row_ror:2 row_mask:0xf bank_mask:0xf
    s_nop 1
    v_add_f32_dpp v60, v60, v60 row_ror:4 row_mask:0xf bank_mask:0xf
    s_nop 1
    v_add_f32_dpp v60, v60, v60 row_ror:8 row_mask:0xf bank_mask:0xf
    v_mov_b32 v61, v60
    s_nop 1
    v_permlane16_swap_b32 v60, v61
    v_add_f32 v60, v60, v61
    v_mov_b32 v61, v60
    s_nop 1
    v_permlane32_swap_b32 v60, v61
    v_add_f32 v60, v60, v61
    v_mul_f32 v60, 0x3b000000, v60
    v_sub_f32 v44, v44, v60
    v_sub_f32 v45, v45, v60
    v_sub_f32 v46, v46, v60
    v_sub_f32 v47, v47, v60
    v_sub_f32 v48, v48, v60
    v_sub_f32 v49, v49, v60
    v_sub_f32 v50, v50, v60
    v_sub_f32 v51, v51, v60
    v_mul_f32 v62, v44, v44
    v_fmac_f32 v62, v45, v45
    v_fmac_f32 v62, v46, v46
    v_fmac_f32 v62, v47, v47
    v_fmac_f32 v62, v48, v48
    v_fmac_f32 v62, v49, v49
    v_fmac_f32 v62, v50, v50
    v_fmac_f32 v62, v51, v51
    s_nop 1
    v_add_f32_dpp v62, v62, v62 row_ror:1 row_mask:0xf bank_mask:0xf
    s_nop 1
    v_add_f32_dpp v62, v62, v62 row_ror:2 row_mask:0xf bank_mask:0xf
    s_nop 1
    v_add_f32_dpp v62, v62, v62 row_ror:4 row_mask:0xf bank_mask:0xf
    s_nop 1
    v_add_f32_dpp v62, v62, v62 row_ror:8 row_mask:0xf bank_mask:0xf
    v_mov_b32 v61, v62
    s_nop 1
    v_permlane16_swap_b32 v62, v61
    v_add_f32 v62, v62, v61
    v_mov_b32 v61, v62
    s_nop 1
    v_permlane32_swap_b32 v62, v61
    v_add_f32 v62, v62, v61
    v_mov_b32 v63, 0x3727c5ac
    v_fmac_f32 v63, 0x3b000000, v62
    v_rsq_f32 v63, v63
    v_lshlrev_b32 v44, 16, v36
    v_and_b32 v45, 0xffff0000, v36
    v_lshlrev_b32 v46, 16, v37
    v_and_b32 v47, 0xffff0000, v37
    v_sub_f32 v44, v44, v60
    v_sub_f32 v45, v45, v60
    v_sub_f32 v46, v46, v60
    v_sub_f32 v47, v47, v60
    v_mul_f32 v44, v44, v63
    v_mul_f32 v45, v45, v63
    v_mul_f32 v46, v46, v63
    v_mul_f32 v47, v47, v63
    s_waitcnt vmcnt(8)
    v_perm_b32 v12, v68, v64, s14
    v_perm_b32 v13, v76, v72, s14
    v_perm_b32 v14, v84, v80, s14
    v_perm_b32 v15, v92, v88, s14
    v_accvgpr_write_b32 a0, v12
    v_accvgpr_write_b32 a1, v13
    v_accvgpr_write_b32 a2, v14
    v_accvgpr_write_b32 a3, v15
    v_perm_b32 v16, v68, v64, s15
    v_perm_b32 v17, v76, v72, s15
    v_perm_b32 v18, v84, v80, s15
    v_perm_b32 v19, v92, v88, s15
    v_accvgpr_write_b32 a4, v16
    v_accvgpr_write_b32 a5, v17
    v_accvgpr_write_b32 a6, v18
    v_accvgpr_write_b32 a7, v19
    v_perm_b32 v12, v69, v65, s14
    v_perm_b32 v13, v77, v73, s14
    v_perm_b32 v14, v85, v81, s14
    v_perm_b32 v15, v93, v89, s14
    v_accvgpr_write_b32 a8, v12
    v_accvgpr_write_b32 a9, v13
    v_accvgpr_write_b32 a10, v14
    v_accvgpr_write_b32 a11, v15
    v_perm_b32 v16, v69, v65, s15
    v_perm_b32 v17, v77, v73, s15
    v_perm_b32 v18, v85, v81, s15
    v_perm_b32 v19, v93, v89, s15
    v_accvgpr_write_b32 a12, v16
    v_accvgpr_write_b32 a13, v17
    v_accvgpr_write_b32 a14, v18
    v_accvgpr_write_b32 a15, v19
    v_perm_b32 v12, v70, v66, s14
    v_perm_b32 v13, v78, v74, s14
    v_perm_b32 v14, v86, v82, s14
    v_perm_b32 v15, v94, v90, s14
    v_accvgpr_write_b32 a16, v12
    v_accvgpr_write_b32 a17, v13
    v_accvgpr_write_b32 a18, v14
    v_accvgpr_write_b32 a19, v15
    v_perm_b32 v16, v70, v66, s15
    v_perm_b32 v17, v78, v74, s15
    v_perm_b32 v18, v86, v82, s15
    v_perm_b32 v19, v94, v90, s15
    v_accvgpr_write_b32 a20, v16
    v_accvgpr_write_b32 a21, v17
    v_accvgpr_write_b32 a22, v18
    v_accvgpr_write_b32 a23, v19
    v_perm_b32 v12, v71, v67, s14
    v_perm_b32 v13, v79, v75, s14
    v_perm_b32 v14, v87, v83, s14
    v_perm_b32 v15, v95, v91, s14
    v_accvgpr_write_b32 a24, v12
    v_accvgpr_write_b32 a25, v13
    v_accvgpr_write_b32 a26, v14
    v_accvgpr_write_b32 a27, v15
    v_perm_b32 v16, v71, v67, s15
    v_perm_b32 v17, v79, v75, s15
    v_perm_b32 v18, v87, v83, s15
    v_perm_b32 v19, v95, v91, s15
    v_accvgpr_write_b32 a28, v16
    v_accvgpr_write_b32 a29, v17
    v_accvgpr_write_b32 a30, v18
    v_accvgpr_write_b32 a31, v19
    s_waitcnt vmcnt(0)
    v_perm_b32 v12, v100, v96, s14
    v_perm_b32 v13, v108, v104, s14
    v_perm_b32 v14, v116, v112, s14
    v_perm_b32 v15, v124, v120, s14
    v_accvgpr_write_b32 a32, v12
    v_accvgpr_write_b32 a33, v13
    v_accvgpr_write_b32 a34, v14
    v_accvgpr_write_b32 a35, v15
    v_perm_b32 v16, v100, v96, s15
    v_perm_b32 v17, v108, v104, s15
    v_perm_b32 v18, v116, v112, s15
    v_perm_b32 v19, v124, v120, s15
    v_accvgpr_write_b32 a36, v16
    v_accvgpr_write_b32 a37, v17
    v_accvgpr_write_b32 a38, v18
    v_accvgpr_write_b32 a39, v19
    v_perm_b32 v12, v101, v97, s14
    v_perm_b32 v13, v109, v105, s14
    v_perm_b32 v14, v117, v113, s14
    v_perm_b32 v15, v125, v121, s14
    v_accvgpr_write_b32 a40, v12
    v_accvgpr_write_b32 a41, v13
    v_accvgpr_write_b32 a42, v14
    v_accvgpr_write_b32 a43, v15
    v_perm_b32 v16, v101, v97, s15
    v_perm_b32 v17, v109, v105, s15
    v_perm_b32 v18, v117, v113, s15
    v_perm_b32 v19, v125, v121, s15
    v_accvgpr_write_b32 a44, v16
    v_accvgpr_write_b32 a45, v17
    v_accvgpr_write_b32 a46, v18
    v_accvgpr_write_b32 a47, v19
    v_perm_b32 v12, v102, v98, s14
    v_perm_b32 v13, v110, v106, s14
    v_perm_b32 v14, v118, v114, s14
    v_perm_b32 v15, v126, v122, s14
    v_accvgpr_write_b32 a48, v12
    v_accvgpr_write_b32 a49, v13
    v_accvgpr_write_b32 a50, v14
    v_accvgpr_write_b32 a51, v15
    v_perm_b32 v16, v102, v98, s15
    v_perm_b32 v17, v110, v106, s15
    v_perm_b32 v18, v118, v114, s15
    v_perm_b32 v19, v126, v122, s15
    v_accvgpr_write_b32 a52, v16
    v_accvgpr_write_b32 a53, v17
    v_accvgpr_write_b32 a54, v18
    v_accvgpr_write_b32 a55, v19
    v_perm_b32 v12, v103, v99, s14
    v_perm_b32 v13, v111, v107, s14
    v_perm_b32 v14, v119, v115, s14
    v_perm_b32 v15, v127, v123, s14
    v_accvgpr_write_b32 a56, v12
    v_accvgpr_write_b32 a57, v13
    v_accvgpr_write_b32 a58, v14
    v_accvgpr_write_b32 a59, v15
    v_perm_b32 v16, v103, v99, s15
    v_perm_b32 v17, v111, v107, s15
    v_perm_b32 v18, v119, v115, s15
    v_perm_b32 v19, v127, v123, s15
    v_accvgpr_write_b32 a60, v16
    v_accvgpr_write_b32 a61, v17
    v_accvgpr_write_b32 a62, v18
    v_accvgpr_write_b32 a63, v19
    s_lshl_b32 s7, s3, 8
    v_lshl_add_u32 v25, v25, 1, s7
    s_waitcnt lgkmcnt(0)
    s_mul_i32 s6, s86, 0x9e3779b1
    s_add_u32 s6, s6, 0x7f4a7c15
    s_mov_b32 s7, 0
    s_branch L_go_19
L_poll_18:
    s_add_u32 s7, s7, 1
    s_cmp_ge_u32 s7, 200000
    s_cbranch_scc1 L_end
L_go_19:
    global_load_dwordx4 v[48:51], v27, s[8:9] sc1
    s_waitcnt vmcnt(0)
    v_min_u32 v32, v49, v51
    v_max_u32 v33, v49, v51
    v_cmp_ne_u32 vcc, s6, v32
    v_cmp_ne_u32 s[12:13], s6, v33
    s_nop 0
    s_or_b64 s[12:13], s[12:13], vcc
    s_cbranch_scc1 L_poll_18
    v_mov_b32 v52, v48
    v_mov_b32 v53, v50
    s_nop 0
    v_permlane32_swap_b32 v48, v52
    v_permlane32_swap_b32 v50, v53
    v_lshlrev_b32 v54, 16, v48
    v_and_b32 v55, 0xffff0000, v48
    v_lshlrev_b32 v56, 16, v50
    v_and_b32 v57, 0xffff0000, v50
    v_lshlrev_b32 v58, 16, v52
    v_and_b32 v59, 0xffff0000, v52
    v_lshlrev_b32 v60, 16, v53
    v_and_b32 v61, 0xffff0000, v53
    v_add_f32 v58, 1.0, v58
    v_add_f32 v59, 1.0, v59
    v_add_f32 v60, 1.0, v60
    v_add_f32 v61, 1.0, v61
    v_fma_f32 v44, v44, v58, v54
    v_fma_f32 v45, v45, v59, v55
    v_fma_f32 v46, v46, v60, v56
    v_fma_f32 v47, v47, v61, v57
    v_cvt_pk_bf16_f32 v48, v44, v45
    v_cvt_pk_bf16_f32 v49, v46, v47
    ds_write_b64 v26, v[48:49] offset:5120
    s_waitcnt lgkmcnt(0)
    ds_read_b128 v[12:15], v25 offset:5120
    ds_read_b128 v[16:19], v25 offset:5248
    s_waitcnt lgkmcnt(1)
    v_mfma_f32_16x16x32_bf16 v[32:35], v[12:15], a[0:3], 0
    v_mfma_f32_16x16x32_bf16 v[36:39], v[12:15], a[4:7], 0
    v_mfma_f32_16x16x32_bf16 v[40:43], v[12:15], a[8:11], 0
    v_mfma_f32_16x16x32_bf16 v[44:47], v[12:15], a[12:15], 0
    v_mfma_f32_16x16x32_bf16 v[48:51], v[12:15], a[16:19], 0
    v_mfma_f32_16x16x32_bf16 v[52:55], v[12:15], a[20:23], 0
    v_mfma_f32_16x16x32_bf16 v[56:59], v[12:15], a[24:27], 0
    v_mfma_f32_16x16x32_bf16 v[60:63], v[12:15], a[28:31], 0
    s_waitcnt lgkmcnt(0)
    v_mfma_f32_16x16x32_bf16 v[32:35], v[16:19], a[32:35], v[32:35]
    v_mfma_f32_16x16x32_bf16 v[36:39], v[16:19], a[36:39], v[36:39]
    v_mfma_f32_16x16x32_bf16 v[40:43], v[16:19], a[40:43], v[40:43]
    v_mfma_f32_16x16x32_bf16 v[44:47], v[16:19], a[44:47], v[44:47]
    v_mfma_f32_16x16x32_bf16 v[48:51], v[16:19], a[48:51], v[48:51]
    v_mfma_f32_16x16x32_bf16 v[52:55], v[16:19], a[52:55], v[52:55]
    v_mfma_f32_16x16x32_bf16 v[56:59], v[16:19], a[56:59], v[56:59]
    v_mfma_f32_16x16x32_bf16 v[60:63], v[16:19], a[60:63], v[60:63]
    s_nop 0
    v_add_f32_dpp v104, v33, v32 row_ror:8 row_mask:0xf bank_mask:0xf
    v_add_f32_dpp v105, v37, v36 row_ror:8 row_mask:0xf bank_mask:0xf
    v_add_f32_dpp v106, v41, v40 row_ror:8 row_mask:0xf bank_mask:0xf
    v_add_f32_dpp v107, v45, v44 row_ror:8 row_mask:0xf bank_mask:0xf
    v_add_f32_dpp v108, v49, v48 row_ror:8 row_mask:0xf bank_mask:0xf
    v_add_f32_dpp v109, v53, v52 row_ror:8 row_mask:0xf bank_mask:0xf
    v_add_f32_dpp v110, v57, v56 row_ror:8 row_mask:0xf bank_mask:0xf
    v_add_f32_dpp v111, v61, v60 row_ror:8 row_mask:0xf bank_mask:0xf
    v_lshlrev_b32 v112, 5, v0
    s_lshl_b32 s7, s3, 8
    v_add_u32 v112, s7, v112
    s_lshl_b32 s7, s3, 2
    v_mov_b32 v113, s7
    v_mov_b32 v35, s6
    s_mov_b64 exec, 0xff
    ds_write_b128 v112, v[104:107] offset:1024
    ds_write_b128 v112, v[108:111] offset:1040
    s_waitcnt lgkmcnt(0)
    ds_write_b32 v113, v11 offset:21776
    s_mov_b64 exec, -1
    s_cmp_lg_u32 s3, 0
    s_cbranch_scc1 L_common
    v_lshlrev_b32 v112, 3, v0
    s_lshl_b32 s7, s81, 8
    s_add_u32 s7, s7, 81920
    v_add_u32 v113, s7, v112
    v_mov_b32 v114, 0
    s_mov_b32 s7, 0
    s_branch L_go_21
L_poll_20:
    s_add_u32 s7, s7, 1
    s_cmp_ge_u32 s7, 200000
    s_cbranch_scc1 L_end
L_go_21:
    ds_read_b128 v[36:39], v114 offset:21776
    s_waitcnt lgkmcnt(0)
    v_and_b32 v36, v36, v37
    v_and_b32 v38, v38, v39
    v_and_b32 v36, v36, v38
    s_nop 0
    v_readfirstlane_b32 s65, v36
    s_nop 0
    s_cmp_eq_u32 s65, 0
    s_cbranch_scc1 L_poll_20
    ds_read_b64 v[36:37], v112 offset:1024
    ds_read_b64 v[38:39], v112 offset:1280
    ds_read_b64 v[40:41], v112 offset:1536
    ds_read_b64 v[42:43], v112 offset:1792
    s_waitcnt lgkmcnt(0)
    v_add_f32 v36, v36, v38
    v_add_f32 v37, v37, v39
    v_add_f32 v40, v40, v42
    v_add_f32 v41, v41, v43
    v_add_f32 v36, v36, v40
    v_add_f32 v37, v37, v41
    v_cvt_pk_bf16_f32 v34, v36, v37
    s_mov_b64 exec, 0xffffffff
    global_store_dwordx2 v113, v[34:35], s[8:9] sc1
    s_mov_b64 exec, -1
    s_branch L_common
L_roleT2:
    s_mov_b32 s80, 3
    s_lshl_b32 s81, s4, 3
    s_add_u32 s81, s81, s5
    s_sub_u32 s81, s81, 14
    s_mov_b32 s48, s24
    s_mov_b32 s49, s25
    s_mov_b32 s50, 4194304
    s_mov_b32 s51, 0x20000
    v_lshlrev_b32 v112, 13, v28
    v_lshl_add_u32 v112, v29, 4, v112
    s_lshr_b32 s66, s81, 2
    s_lshl_b32 s66, s66, 18
    s_lshl_b32 s7, s3, 15
    s_add_u32 s66, s66, s7
    s_and_b32 s7, s81, 3
    s_lshl_b32 s7, s7, 8
    s_add_u32 s66, s66, s7
    s_lshl_b32 s67, s3, 13
    s_add_u32 s67, s67, 22528
    s_mov_b32 m0, s67
    s_nop 0
    buffer_load_dwordx4 v112, s[48:51], s66 offen nt lds
    s_add_u32 s66, s66, 1024
    s_add_u32 s67, s67, 1024
    s_mov_b32 m0, s67
    s_nop 0
    buffer_load_dwordx4 v112, s[48:51], s66 offen nt lds
    s_add_u32 s66, s66, 1024
    s_add_u32 s67, s67, 1024
    s_mov_b32 m0, s67
    s_nop 0
    buffer_load_dwordx4 v112, s[48:51], s66 offen nt lds
    s_add_u32 s66, s66, 1024
    s_add_u32 s67, s67, 1024
    s_mov_b32 m0, s67
    s_nop 0
    buffer_load_dwordx4 v112, s[48:51], s66 offen nt lds
    s_add_u32 s66, s66, 1024
    s_add_u32 s67, s67, 1024
    s_mov_b32 m0, s67
    s_nop 0
    buffer_load_dwordx4 v112, s[48:51], s66 offen nt lds
    s_add_u32 s66, s66, 1024
    s_add_u32 s67, s67, 1024
    s_mov_b32 m0, s67
    s_nop 0
    buffer_load_dwordx4 v112, s[48:51], s66 offen nt lds
    s_add_u32 s66, s66, 1024
    s_add_u32 s67, s67, 1024
    s_mov_b32 m0, s67
    s_waitcnt vmcnt(5)
    buffer_load_dwordx4 v112, s[48:51], s66 offen nt lds
    s_add_u32 s66, s66, 1024
    s_add_u32 s67, s67, 1024
    s_mov_b32 m0, s67
    s_waitcnt vmcnt(5)
    buffer_load_dwordx4 v112, s[48:51], s66 offen nt lds
    s_branch L_common0
L_roleMLP:
    s_mov_b32 s80, 4
    s_lshr_b32 s81, s4, 1
    s_mul_i32 s81, s81, 7
    s_and_b32 s7, s4, 1
    s_lshl_b32 s7, s7, 2
    s_add_u32 s81, s81, s7
    s_add_u32 s81, s81, s5
    s_sub_u32 s81, s81, 22
    s_mov_b32 s48, s28
    s_mov_b32 s49, s29
    s_mov_b32 s50, 1835008
    s_mov_b32 s51, 0x20000
    s_mov_b32 s52, s30
    s_mov_b32 s53, s31
    s_mov_b32 s54, 1835008
    s_mov_b32 s55, 0x20000
    s_movk_i32 s7, 3584
    v_mul_lo_u32 v112, v27, s7
    v_add_u32 v112, v112, v26
    v_lshlrev_b32 v113, 10, v27
    v_add_u32 v113, v113, v26
    s_mul_i32 s66, s3, 229376
    s_lshl_b32 s7, s81, 7
    s_add_u32 s66, s66, s7
    s_lshl_b32 s67, s3, 13
    s_add_u32 s67, s67, 22528
    s_mov_b32 m0, s67
    s_nop 0
    buffer_load_dwordx4 v112, s[48:51], s66 offen nt lds
    s_add_u32 s66, s66, 3584
    s_add_u32 s67, s67, 1024
    s_mov_b32 m0, s67
    s_nop 0
    buffer_load_dwordx4 v112, s[48:51], s66 offen nt lds
    s_add_u32 s66, s66, 3584
    s_add_u32 s67, s67, 1024
    s_mov_b32 m0, s67
    s_nop 0
    buffer_load_dwordx4 v112, s[48:51], s66 offen nt lds
    s_add_u32 s66, s66, 3584
    s_add_u32 s67, s67, 1024
    s_mov_b32 m0, s67
    s_nop 0
    buffer_load_dwordx4 v112, s[48:51], s66 offen nt lds
    s_add_u32 s66, s66, 3584
    s_add_u32 s67, s67, 1024
    s_mov_b32 m0, s67
    s_nop 0
    buffer_load_dwordx4 v112, s[48:51], s66 offen nt lds
    s_add_u32 s66, s66, 3584
    s_add_u32 s67, s67, 1024
    s_mov_b32 m0, s67
    s_nop 0
    buffer_load_dwordx4 v112, s[48:51], s66 offen nt lds
    s_add_u32 s66, s66, 3584
    s_add_u32 s67, s67, 1024
    s_mov_b32 m0, s67
    s_waitcnt vmcnt(5)
    buffer_load_dwordx4 v112, s[48:51], s66 offen nt lds
    s_add_u32 s66, s66, 3584
    s_add_u32 s67, s67, 1024
    s_mov_b32 m0, s67
    s_waitcnt vmcnt(5)
    buffer_load_dwordx4 v112, s[48:51], s66 offen nt lds
    s_lshl_b32 s66, s81, 16
    s_lshl_b32 s7, s3, 7
    s_add_u32 s66, s66, s7
    s_lshl_b32 s67, s3, 13
    s_add_u32 s67, s67, 88064
    s_mov_b32 m0, s67
    s_waitcnt vmcnt(5)
    buffer_load_dwordx4 v113, s[52:55], s66 offen nt lds
    s_add_u32 s66, s66, 1024
    s_add_u32 s67, s67, 1024
    s_mov_b32 m0, s67
    s_waitcnt vmcnt(5)
    buffer_load_dwordx4 v113, s[52:55], s66 offen nt lds
    s_add_u32 s66, s66, 1024
    s_add_u32 s67, s67, 1024
    s_mov_b32 m0, s67
    s_waitcnt vmcnt(5)
    buffer_load_dwordx4 v113, s[52:55], s66 offen nt lds
    s_add_u32 s66, s66, 1024
    s_add_u32 s67, s67, 1024
    s_mov_b32 m0, s67
    s_waitcnt vmcnt(5)
    buffer_load_dwordx4 v113, s[52:55], s66 offen nt lds
    s_add_u32 s66, s66, 1024
    s_add_u32 s67, s67, 1024
    s_mov_b32 m0, s67
    s_waitcnt vmcnt(5)
    buffer_load_dwordx4 v113, s[52:55], s66 offen nt lds
    s_add_u32 s66, s66, 1024
    s_add_u32 s67, s67, 1024
    s_mov_b32 m0, s67
    s_waitcnt vmcnt(5)
    buffer_load_dwordx4 v113, s[52:55], s66 offen nt lds
    s_add_u32 s66, s66, 1024
    s_add_u32 s67, s67, 1024
    s_mov_b32 m0, s67
    s_waitcnt vmcnt(5)
    buffer_load_dwordx4 v113, s[52:55], s66 offen nt lds
    s_add_u32 s66, s66, 1024
    s_add_u32 s67, s67, 1024
    s_mov_b32 m0, s67
    s_waitcnt vmcnt(5)
    buffer_load_dwordx4 v113, s[52:55], s66 offen nt lds
    s_branch L_common0
.section .rodata,"a"
.p2align 6
.amdhsa_kernel adaLN_cond__gqa_block_cached__dense_activation_silu__decode_kernel
  .amdhsa_next_free_vgpr 224
  .amdhsa_next_free_sgpr 100
  .amdhsa_accum_offset 160
  .amdhsa_group_segment_fixed_size 0
  .amdhsa_kernarg_size 104
  .amdhsa_user_sgpr_count 2
  .amdhsa_user_sgpr_kernarg_segment_ptr 1
  .amdhsa_system_sgpr_workgroup_id_x 1
.end_amdhsa_kernel
```
